```python
import torch

def _softmax(x, axis=-1):
    return torch.softmax(x, dim=axis)
def _gelu(x):
    return torch.nn.functional.gelu(x, approximate="tanh")
def _silu(x):
    return torch.nn.functional.silu(x)
def _sigmoid(x):
    return torch.sigmoid(x)
def _layernorm(x, axis=-1, eps=1e-5):
    m = x.mean(dim=axis, keepdim=True)
    v = x.var(dim=axis, keepdim=True, unbiased=False)
    return (x - m) / torch.sqrt(v + eps)
def _scatter_add(tgt, idx, src, axis=0):
    return tgt.clone().index_add_(axis, idx, src)
def _segment_sum(src, seg, n):
    out = torch.zeros((n,) + src.shape[1:], dtype=src.dtype)
    return out.index_add_(0, seg, src)
def _pad(x, pw):
    flat = tuple(v for pair in reversed(pw) for v in pair)
    return torch.nn.functional.pad(x, flat)

kernel_name = 'sequential_preLN__compressed_kv_cla__glu_gated_geglu__decode'

def setup_inputs():

    _w = (lambda a: (lambda t: t.to(torch.bfloat16) if t.is_floating_point() else t)(torch.as_tensor(a)))
    def _A_setup():
        B, H, Sq, Sk, D, M = 4, 32, 1, 8192, 128, 512
        Dc = 4 * D
        return {
            "x": _w((lambda *s: torch.randn(*s, dtype=torch.bfloat16) * 0.05)(B, Sq, M)),
            "c_kv": _w((lambda *s: torch.randn(*s, dtype=torch.bfloat16) * 0.8)(B, Sk, Dc)),
            "w_q": _w((lambda *s: torch.randn(*s, dtype=torch.bfloat16) * 1.6)(M, H, D) * (M ** -0.5)),
            "w_uk": _w((lambda *s: torch.randn(*s, dtype=torch.bfloat16) * 1.6)(Dc, H, D) * (Dc ** -0.5)),
            "w_uv": _w((lambda *s: torch.randn(*s, dtype=torch.bfloat16) * 0.8)(Dc, H, D) * (Dc ** -0.5)),
            "w_o": _w((lambda *s: torch.randn(*s, dtype=torch.bfloat16) * 0.8)(H, D, M) * ((H * D) ** -0.5)),
        }
    _A_in = _A_setup()

    def _B_setup():
        B, S, Dm, Df = 4, 1, 512, 1376
        return {
            "x": _w((lambda *s: torch.randn(*s, dtype=torch.bfloat16) * 0.05)(B, S, Dm)),
            "w_gate": _w((lambda *s: torch.randn(*s, dtype=torch.bfloat16) * 0.4)(Dm, Df) * (Dm ** -0.5)),
            "w_up": _w((lambda *s: torch.randn(*s, dtype=torch.bfloat16) * 0.4)(Dm, Df) * (Dm ** -0.5)),
            "w_down": _w((lambda *s: torch.randn(*s, dtype=torch.bfloat16) * 0.4)(Df, Dm) * (Df ** -0.5)),
        }
    _B_in = _B_setup()

    return {
        "A_x": _A_in["x"],
        "A_c_kv": _A_in["c_kv"],
        "A_w_q": _A_in["w_q"],
        "A_w_uk": _A_in["w_uk"],
        "A_w_uv": _A_in["w_uv"],
        "A_w_o": _A_in["w_o"],
        "B_x": _B_in["x"],
        "B_w_gate": _B_in["w_gate"],
        "B_w_up": _B_in["w_up"],
        "B_w_down": _B_in["w_down"],
    }

def reference(A_x, A_c_kv, A_w_q, A_w_uk, A_w_uv, A_w_o, B_x, B_w_gate, B_w_up, B_w_down):
    def _A_ref(x, c_kv, w_q, w_uk, w_uv, w_o):
        B, Sq, M = x.shape[0], x.shape[1], x.shape[2]
        Sk = c_kv.shape[1]
        H, D = w_q.shape[1], w_q.shape[2]
        q = torch.einsum("bqm,mhd->bhqd", x, w_q)
        k = torch.einsum("bkc,chd->bhkd", c_kv, w_uk)
        v = torch.einsum("bkc,chd->bhkd", c_kv, w_uv)
        scores = torch.einsum("bhqd,bhkd->bhqk", q, k) * (D ** -0.5)
        off = Sk - Sq
        qi = torch.arange(Sq)[:, None]
        kj = torch.arange(Sk)[None, :]
        cmask = kj <= (qi + off)
        scores = torch.where(cmask[None, None], scores, -1e9)
        p = _softmax(scores, axis=-1)
        ctx = torch.einsum("bhqk,bhkd->bhqd", p, v)
        return torch.einsum("bhqd,hdm->bqm", ctx, w_o)

    def _B_ref(x, w_gate, w_up, w_down):
        g = torch.einsum("bsd,df->bsf", x, w_gate)
        u = torch.einsum("bsd,df->bsf", x, w_up)
        h = _gelu(g) * u
        return torch.einsum("bsf,fd->bsd", h, w_down)

    x = A_x
    h = x + _A_ref(_layernorm(x, axis=-1), A_c_kv, A_w_q, A_w_uk, A_w_uv, A_w_o)
    h2 = h + _B_ref(_layernorm(h, axis=-1), B_w_gate, B_w_up, B_w_down)
    return h2
```

```asm
; @launch grid=(256,1,1) block=(512,1,1) lds=163840
.amdgcn_target "amdgcn-amd-amdhsa--gfx950"
.text
.globl sequential_preLN__compressed_kv_cla__glu_gated_geglu__decode_kernel
.p2align 8
.type sequential_preLN__compressed_kv_cla__glu_gated_geglu__decode_kernel,@function
sequential_preLN__compressed_kv_cla__glu_gated_geglu__decode_kernel:
    s_cmp_ge_u32 s2, 256
    s_cbranch_scc1 L_end
    s_load_dwordx16 s[64:79], s[0:1], 0
    s_load_dwordx8 s[80:87], s[0:1], 64
    s_load_dwordx2 s[12:13], s[0:1], 96
    s_cmp_lt_u32 s2, 128
    s_cbranch_scc1 L_nopf
    s_getpc_b64 s[94:95]
L_pc:
    v_lshlrev_b32 v1, 7, v0
    v_cmp_gt_u32 vcc, L_end-L_pc, v1
    s_nop 0
    s_and_saveexec_b64 s[96:97], vcc
    s_nop 1
    s_cbranch_execz L_pfdone
    global_load_dword v127, v1, s[94:95]
L_pfdone:
    s_mov_b64 exec, s[96:97]
L_nopf:
    v_and_b32 v1, 63, v0
    v_lshrrev_b32 v2, 6, v0
    s_nop 0
    v_readfirstlane_b32 s3, v2
    v_lshlrev_b32 v2, 4, v1
    v_lshrrev_b32 v3, 4, v1
    v_and_b32 v4, 3, v1
    v_and_b32 v11, 15, v1
    s_mov_b32 s14, 5767168
    s_mov_b32 s15, 0x00020000
    s_mov_b32 s10, 4096
    s_mov_b32 s11, 0x00020000
    s_cmp_ge_u32 s2, 128
    s_cbranch_scc1 L_att
    s_mov_b32 s22, 4194304
    s_mov_b32 s23, 0x00020000
    s_mov_b32 s26, 4194304
    s_mov_b32 s27, 0x00020000
    s_and_b32 s4, s2, 7
    s_lshl_b32 s4, s4, 2
    s_bfe_u32 s5, s2, 0x20003
    s_add_u32 s4, s4, s5
    s_lshr_b32 s5, s2, 5
    s_lshl_b32 s6, s4, 8
    v_lshlrev_b32 v5, 1, v3
    v_xor_b32 v5, v5, v11
    v_lshlrev_b32 v5, 4, v5
    v_lshl_add_u32 v6, v3, 13, v5
    v_xor_b32 v7, 0x80, v6
    v_xor_b32 v8, v3, v11
    v_lshlrev_b32 v8, 4, v8
    v_lshl_add_u32 v8, v3, 13, v8
    s_lshl_b32 s90, s5, 20
    s_lshl_b32 s91, s3, 17
    s_add_u32 s90, s90, s91
    s_add_u32 s90, s90, s6
    s_lshl_b32 s91, s3, 12
    s_mov_b32 m0, s91
    v_bfe_u32 v10, v1, 2, 2
    v_lshlrev_b32 v10, 6, v10
    v_lshl_add_u32 v10, v4, 10, v10
    v_lshl_add_u32 v10, v3, 4, v10
    s_lshl_b32 s93, s5, 8
    s_waitcnt lgkmcnt(0)
    s_mov_b64 s[8:9], s[64:65]
    s_mov_b64 s[20:21], s[68:69]
    s_mov_b64 s[24:25], s[70:71]
    s_cmp_lg_u32 s3, 0
    s_cbranch_scc1 L_nox
    buffer_load_dwordx4 v[12:15], v10, s[8:11], 0 offen offset:0
    buffer_load_dwordx4 v[16:19], v10, s[8:11], 0 offen offset:256
    buffer_load_dwordx4 v[20:23], v10, s[8:11], 0 offen offset:512
    buffer_load_dwordx4 v[24:27], v10, s[8:11], 0 offen offset:768
    buffer_load_dwordx4 v[28:31], v10, s[8:11], s93 offen
L_nox:
    s_add_u32 s92, s90, 0
    buffer_load_dwordx4 v6, s[20:23], s92 offen nt lds
    s_add_u32 m0, m0, 1024
    s_add_u32 s92, s90, 32768
    buffer_load_dwordx4 v6, s[20:23], s92 offen nt lds
    s_add_u32 m0, m0, 1024
    s_add_u32 s92, s90, 65536
    buffer_load_dwordx4 v7, s[20:23], s92 offen nt lds
    s_add_u32 m0, m0, 1024
    s_add_u32 s92, s90, 98304
    buffer_load_dwordx4 v7, s[20:23], s92 offen nt lds
    s_barrier
    s_cmp_lt_u32 s3, 4
    s_cbranch_scc1 L_nouk
    s_lshl_b32 s91, s3, 17
    s_add_u32 s90, s90, s91
    s_sub_u32 s90, s90, 1048576
    s_lshl_b32 s91, s3, 13
    s_add_u32 m0, s91, 0
    v_xor_b32 v9, 0, v8
    s_add_u32 s92, s90, 0
    buffer_load_dwordx4 v9, s[24:27], s92 offen nt lds
    s_add_u32 m0, m0, 1024
    s_add_u32 s92, s90, 32768
    buffer_load_dwordx4 v9, s[24:27], s92 offen nt lds
    s_add_u32 m0, m0, 1024
    v_xor_b32 v9, 64, v8
    s_add_u32 s92, s90, 65536
    buffer_load_dwordx4 v9, s[24:27], s92 offen nt lds
    s_add_u32 m0, m0, 1024
    s_add_u32 s92, s90, 98304
    buffer_load_dwordx4 v9, s[24:27], s92 offen nt lds
    s_add_u32 m0, m0, 1024
    v_xor_b32 v9, 128, v8
    s_add_u32 s92, s90, 131072
    buffer_load_dwordx4 v9, s[24:27], s92 offen nt lds
    s_add_u32 m0, m0, 1024
    s_add_u32 s92, s90, 163840
    buffer_load_dwordx4 v9, s[24:27], s92 offen nt lds
    s_add_u32 m0, m0, 1024
    v_xor_b32 v9, 192, v8
    s_add_u32 s92, s90, 196608
    buffer_load_dwordx4 v9, s[24:27], s92 offen nt lds
    s_add_u32 m0, m0, 1024
    s_add_u32 s92, s90, 229376
    buffer_load_dwordx4 v9, s[24:27], s92 offen nt lds
L_nouk:
    s_load_dword s56, s[12:13], 192512
    s_mov_b64 s[28:29], s[72:73]
    s_mov_b64 s[32:33], s[74:75]
    s_mov_b64 s[36:37], s[78:79]
    s_mov_b64 s[40:41], s[80:81]
    s_mov_b64 s[44:45], s[82:83]
    s_mov_b64 s[48:49], s[84:85]
    s_mov_b32 s57, 0x3f803f80
    s_mov_b32 s58, 0x3f80
    s_mov_b32 s59, 0x3f800000
    s_mov_b32 s62, 0xffff0000
    s_cmp_lg_u32 s3, 0
    s_cbranch_scc1 L_noln
    s_waitcnt vmcnt(5)
    v_dot2_f32_bf16 v34, v12, s57, 0
    v_dot2_f32_bf16 v35, v12, v12, 0
    v_dot2_f32_bf16 v34, v13, s57, v34
    v_dot2_f32_bf16 v35, v13, v13, v35
    v_dot2_f32_bf16 v34, v14, s57, v34
    v_dot2_f32_bf16 v35, v14, v14, v35
    v_dot2_f32_bf16 v34, v15, s57, v34
    v_dot2_f32_bf16 v35, v15, v15, v35
    v_dot2_f32_bf16 v34, v16, s57, v34
    v_dot2_f32_bf16 v35, v16, v16, v35
    v_dot2_f32_bf16 v34, v17, s57, v34
    v_dot2_f32_bf16 v35, v17, v17, v35
    v_dot2_f32_bf16 v34, v18, s57, v34
    v_dot2_f32_bf16 v35, v18, v18, v35
    v_dot2_f32_bf16 v34, v19, s57, v34
    v_dot2_f32_bf16 v35, v19, v19, v35
    v_dot2_f32_bf16 v34, v20, s57, v34
    v_dot2_f32_bf16 v35, v20, v20, v35
    v_dot2_f32_bf16 v34, v21, s57, v34
    v_dot2_f32_bf16 v35, v21, v21, v35
    v_dot2_f32_bf16 v34, v22, s57, v34
    v_dot2_f32_bf16 v35, v22, v22, v35
    v_dot2_f32_bf16 v34, v23, s57, v34
    v_dot2_f32_bf16 v35, v23, v23, v35
    v_dot2_f32_bf16 v34, v24, s57, v34
    v_dot2_f32_bf16 v35, v24, v24, v35
    v_dot2_f32_bf16 v34, v25, s57, v34
    v_dot2_f32_bf16 v35, v25, v25, v35
    v_dot2_f32_bf16 v34, v26, s57, v34
    v_dot2_f32_bf16 v35, v26, v26, v35
    v_dot2_f32_bf16 v34, v27, s57, v34
    v_dot2_f32_bf16 v35, v27, v27, v35
    s_nop 1
    v_add_f32_dpp v34, v34, v34 row_ror:4 row_mask:0xf bank_mask:0xf
    v_add_f32_dpp v35, v35, v35 row_ror:4 row_mask:0xf bank_mask:0xf
    s_nop 0
    v_add_f32_dpp v34, v34, v34 row_ror:8 row_mask:0xf bank_mask:0xf
    v_add_f32_dpp v35, v35, v35 row_ror:8 row_mask:0xf bank_mask:0xf
    v_mov_b32 v12, v34
    v_mov_b32 v13, v35
    s_nop 0
    v_permlane16_swap_b32 v34, v12
    v_permlane16_swap_b32 v35, v13
    v_add_f32 v34, v34, v12
    v_add_f32 v35, v35, v13
    v_mov_b32 v12, v34
    v_mov_b32 v13, v35
    s_nop 0
    v_permlane32_swap_b32 v34, v12
    v_permlane32_swap_b32 v35, v13
    v_add_f32 v34, v34, v12
    v_add_f32 v35, v35, v13
    v_mul_f32 v34, 0x3b000000, v34
    v_mul_f32 v35, 0x3b000000, v35
    v_fma_f32 v35, -v34, v34, v35
    v_max_f32 v35, 0, v35
    v_add_f32 v35, 0x3727c5ac, v35
    v_rsq_f32 v35, v35
    s_nop 0
    v_mul_f32 v35, 0x3e0293ee, v35
    v_mul_f32 v34, v34, v35
    s_waitcnt vmcnt(4)
    v_lshlrev_b32 v12, 16, v28
    v_and_b32 v13, s62, v28
    v_fma_f32 v12, v12, v35, -v34
    v_fma_f32 v13, v13, v35, -v34
    v_cvt_pk_bf16_f32 v28, v12, v13
    v_lshlrev_b32 v12, 16, v29
    v_and_b32 v13, s62, v29
    v_fma_f32 v12, v12, v35, -v34
    v_fma_f32 v13, v13, v35, -v34
    v_cvt_pk_bf16_f32 v29, v12, v13
    v_lshlrev_b32 v12, 16, v30
    v_and_b32 v13, s62, v30
    v_fma_f32 v12, v12, v35, -v34
    v_fma_f32 v13, v13, v35, -v34
    v_cvt_pk_bf16_f32 v30, v12, v13
    v_lshlrev_b32 v12, 16, v31
    v_and_b32 v13, s62, v31
    v_fma_f32 v12, v12, v35, -v34
    v_fma_f32 v13, v13, v35, -v34
    v_cvt_pk_bf16_f32 v31, v12, v13
    v_add_u32 v12, 131072, v2
    ds_write_b128 v12, v[28:31]
L_noln:
    s_mov_b32 s30, 4194304
    s_mov_b32 s31, 0x00020000
    s_mov_b32 s34, 4194304
    s_mov_b32 s35, 0x00020000
    s_mov_b32 s38, 1409024
    s_mov_b32 s39, 0x00020000
    s_mov_b32 s42, 1409024
    s_mov_b32 s43, 0x00020000
    s_mov_b32 s46, 1409024
    s_mov_b32 s47, 0x00020000
    s_mov_b32 s50, 4096
    s_mov_b32 s51, 0x00020000
    v_mov_b32 v36, -1
    v_mov_b32 v37, -1
    v_mov_b32 v38, -1
    v_mov_b32 v39, -1
    s_lshl_b32 s92, s2, 3
    s_add_u32 s92, s92, s3
    s_mul_i32 s92, s92, 352
    s_add_u32 s92, s92, 262144
    s_mov_b32 exec_lo, 0x3fffff
    s_mov_b32 exec_hi, 0x0
    buffer_store_dwordx4 v[36:39], v2, s[12:15], s92 offen sc1
    s_mov_b64 exec, -1
    v_bfe_u32 v40, v1, 2, 3
    v_lshlrev_b32 v40, 1, v40
    s_lshl_b32 s92, s3, 1
    s_and_b32 s92, s92, 12
    v_bitop3_b32 v40, v40, v4, s92 bitop3:0x96
    v_lshlrev_b32 v40, 4, v40
    v_bfe_u32 v41, v1, 2, 2
    v_lshl_add_u32 v41, v3, 3, v41
    v_lshl_add_u32 v40, v41, 8, v40
    s_and_b32 s92, s3, 1
    s_lshl_b32 s92, s92, 3
    v_add_u32 v40, s92, v40
    v_lshlrev_b32 v41, 8, v3
    v_lshl_add_u32 v41, v4, 4, v41
    v_add_u32 v41, 131072, v41
    v_lshlrev_b32 v42, 6, v3
    v_lshl_add_u32 v42, v4, 4, v42
    s_lshl_b32 s96, s4, 13
    s_add_u32 s96, s96, 786432
    s_lshl_b32 s92, s5, 11
    s_add_u32 s97, s96, s92
    s_lshl_b32 s92, s3, 8
    s_add_u32 s97, s97, s92
    s_waitcnt lgkmcnt(0)
    s_add_u32 s56, s56, 0x9e3779b9
    s_getreg_b32 s1, hwreg(HW_REG_XCC_ID, 0, 4)
    s_xor_b32 s52, s1, s56
    s_add_u32 s98, s97, 4718592
    s_add_u32 s99, s96, 0
    v_bfe_u32 v43, v1, 2, 2
    v_lshlrev_b32 v43, 11, v43
    v_lshl_add_u32 v43, v3, 6, v43
    v_lshl_add_u32 v43, v4, 4, v43
    s_cmp_lt_u32 s3, 4
    s_cbranch_scc1 L_wq_lo
    s_waitcnt vmcnt(9)
    s_branch L_wq_hi
L_wq_lo:
    s_waitcnt vmcnt(1)
L_wq_hi:
    s_barrier
    ds_read_b64_tr_b16 v[12:13], v40 offset:0
    ds_read_b64_tr_b16 v[14:15], v40 offset:1024
    ds_read_b128 v[44:47], v41 offset:0
    ds_read_b64_tr_b16 v[16:17], v40 offset:8192
    ds_read_b64_tr_b16 v[18:19], v40 offset:9216
    ds_read_b128 v[48:51], v41 offset:64
    ds_read_b64_tr_b16 v[20:21], v40 offset:16384
    ds_read_b64_tr_b16 v[22:23], v40 offset:17408
    ds_read_b128 v[52:55], v41 offset:128
    ds_read_b64_tr_b16 v[24:25], v40 offset:24576
    ds_read_b64_tr_b16 v[26:27], v40 offset:25600
    ds_read_b128 v[56:59], v41 offset:192
    s_waitcnt lgkmcnt(9)
    v_mfma_f32_16x16x32_bf16 v[60:63], v[12:15], v[44:47], 0
    s_waitcnt lgkmcnt(6)
    v_mfma_f32_16x16x32_bf16 v[60:63], v[16:19], v[48:51], v[60:63]
    s_waitcnt lgkmcnt(3)
    v_mfma_f32_16x16x32_bf16 v[60:63], v[20:23], v[52:55], v[60:63]
    s_waitcnt lgkmcnt(0)
    v_mfma_f32_16x16x32_bf16 v[60:63], v[24:27], v[56:59], v[60:63]
    s_nop 7
    v_cvt_pk_bf16_f32 v64, v60, v61
    v_cvt_pk_bf16_f32 v65, v62, v63
    v_bitop3_b32 v66, v64, v65, s56 bitop3:0x96
    s_mov_b32 exec_lo, 0xf000f
    s_mov_b32 exec_hi, 0xf000f
    buffer_store_dwordx4 v[64:67], v42, s[12:15], s97 offen sc1
    s_mov_b64 exec, -1
    s_lshr_b32 s93, s2, 3
    s_bitcmp1_b32 8738, s93
    s_cselect_b32 s98, s3, 99
    v_lshlrev_b32 v30, 7, v1
    v_mov_b32 v31, s56
    s_cmp_lt_u32 s3, 4
    s_cbranch_scc1 L_a2
    s_waitcnt vmcnt(0)
    s_barrier
    s_cmp_lg_u32 s98, 7
    s_cbranch_scc1 arr_1
    v_mov_b32 v23, 0
    v_mov_b32 v22, 1
    s_mov_b64 exec, 1
    global_atomic_add v22, v23, v22, s[86:87] sc0 sc1
    s_mov_b64 exec, -1
arr_1:
    s_branch L_a_done
L_a2:
    s_waitcnt vmcnt(0)
    buffer_load_dwordx4 v[100:103], v43, s[12:15], s99 offen offset:0 sc1
    buffer_load_dwordx4 v[104:107], v43, s[12:15], s99 offen offset:256 sc1
    buffer_load_dwordx4 v[108:111], v43, s[12:15], s99 offen offset:512 sc1
    buffer_load_dwordx4 v[112:115], v43, s[12:15], s99 offen offset:768 sc1
    buffer_load_dwordx4 v[116:119], v43, s[12:15], s99 offen offset:1024 sc1
    buffer_load_dwordx4 v[120:123], v43, s[12:15], s99 offen offset:1280 sc1
    buffer_load_dwordx4 v[124:127], v43, s[12:15], s99 offen offset:1536 sc1
    buffer_load_dwordx4 v[128:131], v43, s[12:15], s99 offen offset:1792 sc1
    v_lshrrev_b32 v12, 2, v11
    v_lshl_add_u32 v12, v12, 3, v4
    v_lshlrev_b32 v12, 8, v12
    v_xor_b32 v13, v3, v11
    v_lshl_add_u32 v12, v13, 4, v12
    s_lshl_b32 s92, s3, 13
    s_add_u32 s92, s92, 32768
    v_add_u32 v12, s92, v12
    s_barrier
    v_xor_b32 v13, 0, v12
    ds_read_b128 v[68:71], v13 offset:0
    ds_read_b128 v[84:87], v13 offset:1024
    v_xor_b32 v13, 64, v12
    ds_read_b128 v[72:75], v13 offset:0
    ds_read_b128 v[88:91], v13 offset:1024
    v_xor_b32 v13, 128, v12
    ds_read_b128 v[76:79], v13 offset:0
    ds_read_b128 v[92:95], v13 offset:1024
    v_xor_b32 v13, 192, v12
    ds_read_b128 v[80:83], v13 offset:0
    ds_read_b128 v[96:99], v13 offset:1024
    v_lshlrev_b32 v15, 8, v4
    v_lshl_add_u32 v15, v3, 4, v15
    s_lshl_b32 s91, s3, 6
    s_add_u32 s91, s91, 132096
    v_add_u32 v15, s91, v15
    v_add_u32 v16, 132096, v2
    v_lshlrev_b32 v20, 15, v3
    v_lshl_add_u32 v20, v11, 4, v20
    v_lshlrev_b32 v21, 5, v3
    v_lshl_add_u32 v21, v4, 3, v21
    s_lshl_b32 s91, s4, 10
    s_lshl_b32 s92, s5, 8
    s_add_u32 s92, s92, s91
    s_lshr_b32 s93, s92, 1
    s_add_u32 s93, s93, 131072
    s_mov_b32 s60, 200000
    s_branch L_a2chk
L_a2poll:
    buffer_load_dwordx4 v[100:103], v43, s[12:15], s99 offen offset:0 sc1
    buffer_load_dwordx4 v[104:107], v43, s[12:15], s99 offen offset:256 sc1
    buffer_load_dwordx4 v[108:111], v43, s[12:15], s99 offen offset:512 sc1
    buffer_load_dwordx4 v[112:115], v43, s[12:15], s99 offen offset:768 sc1
    buffer_load_dwordx4 v[116:119], v43, s[12:15], s99 offen offset:1024 sc1
    buffer_load_dwordx4 v[120:123], v43, s[12:15], s99 offen offset:1280 sc1
    buffer_load_dwordx4 v[124:127], v43, s[12:15], s99 offen offset:1536 sc1
    buffer_load_dwordx4 v[128:131], v43, s[12:15], s99 offen offset:1792 sc1
L_a2chk:
    s_waitcnt vmcnt(7)
    v_bitop3_b32 v102, v100, v101, v102 bitop3:0x96
    s_waitcnt vmcnt(6)
    v_bitop3_b32 v106, v104, v105, v106 bitop3:0x96
    s_waitcnt vmcnt(5)
    v_bitop3_b32 v110, v108, v109, v110 bitop3:0x96
    s_waitcnt vmcnt(4)
    v_bitop3_b32 v114, v112, v113, v114 bitop3:0x96
    s_waitcnt vmcnt(3)
    v_bitop3_b32 v118, v116, v117, v118 bitop3:0x96
    s_waitcnt vmcnt(2)
    v_bitop3_b32 v122, v120, v121, v122 bitop3:0x96
    s_waitcnt vmcnt(1)
    v_bitop3_b32 v126, v124, v125, v126 bitop3:0x96
    s_waitcnt vmcnt(0)
    v_bitop3_b32 v130, v128, v129, v130 bitop3:0x96
    v_max3_u32 v17, v102, v106, v110
    v_min3_u32 v18, v102, v106, v110
    v_max3_u32 v17, v17, v114, v118
    v_min3_u32 v18, v18, v114, v118
    v_max3_u32 v17, v17, v122, v126
    v_min3_u32 v18, v18, v122, v126
    v_max3_u32 v17, v17, v130, s56
    v_min3_u32 v18, v18, v130, s56
    v_cmp_ne_u32 vcc, v17, v18
    s_nop 3
    s_cbranch_vccz L_a2go
    s_sub_u32 s60, s60, 1
    s_cbranch_scc0 L_a2poll
L_a2go:
    s_waitcnt lgkmcnt(0)
    v_mfma_f32_16x16x16_bf16 v[132:135], v[68:69], v[100:101], 0
    v_mfma_f32_16x16x16_bf16 v[136:139], v[84:85], v[100:101], 0
    v_mfma_f32_16x16x16_bf16 v[132:135], v[70:71], v[104:105], v[132:135]
    v_mfma_f32_16x16x16_bf16 v[136:139], v[86:87], v[104:105], v[136:139]
    v_mfma_f32_16x16x16_bf16 v[132:135], v[72:73], v[108:109], v[132:135]
    v_mfma_f32_16x16x16_bf16 v[136:139], v[88:89], v[108:109], v[136:139]
    v_mfma_f32_16x16x16_bf16 v[132:135], v[74:75], v[112:113], v[132:135]
    v_mfma_f32_16x16x16_bf16 v[136:139], v[90:91], v[112:113], v[136:139]
    v_mfma_f32_16x16x16_bf16 v[132:135], v[76:77], v[116:117], v[132:135]
    v_mfma_f32_16x16x16_bf16 v[136:139], v[92:93], v[116:117], v[136:139]
    v_mfma_f32_16x16x16_bf16 v[132:135], v[78:79], v[120:121], v[132:135]
    v_mfma_f32_16x16x16_bf16 v[136:139], v[94:95], v[120:121], v[136:139]
    v_mfma_f32_16x16x16_bf16 v[132:135], v[80:81], v[124:125], v[132:135]
    v_mfma_f32_16x16x16_bf16 v[136:139], v[96:97], v[124:125], v[136:139]
    v_mfma_f32_16x16x16_bf16 v[132:135], v[82:83], v[128:129], v[132:135]
    v_mfma_f32_16x16x16_bf16 v[136:139], v[98:99], v[128:129], v[136:139]
    s_nop 6
    v_add_f32_dpp v132, v132, v132 row_ror:4 row_mask:0xf bank_mask:0xf
    v_add_f32_dpp v133, v133, v133 row_ror:4 row_mask:0xf bank_mask:0xf
    v_add_f32_dpp v134, v134, v134 row_ror:4 row_mask:0xf bank_mask:0xf
    v_add_f32_dpp v135, v135, v135 row_ror:4 row_mask:0xf bank_mask:0xf
    v_add_f32_dpp v136, v136, v136 row_ror:4 row_mask:0xf bank_mask:0xf
    v_add_f32_dpp v137, v137, v137 row_ror:4 row_mask:0xf bank_mask:0xf
    v_add_f32_dpp v138, v138, v138 row_ror:4 row_mask:0xf bank_mask:0xf
    v_add_f32_dpp v139, v139, v139 row_ror:4 row_mask:0xf bank_mask:0xf
    v_add_f32_dpp v132, v132, v132 row_ror:8 row_mask:0xf bank_mask:0xf
    v_add_f32_dpp v133, v133, v133 row_ror:8 row_mask:0xf bank_mask:0xf
    v_add_f32_dpp v134, v134, v134 row_ror:8 row_mask:0xf bank_mask:0xf
    v_add_f32_dpp v135, v135, v135 row_ror:8 row_mask:0xf bank_mask:0xf
    v_add_f32_dpp v136, v136, v136 row_ror:8 row_mask:0xf bank_mask:0xf
    v_add_f32_dpp v137, v137, v137 row_ror:8 row_mask:0xf bank_mask:0xf
    v_add_f32_dpp v138, v138, v138 row_ror:8 row_mask:0xf bank_mask:0xf
    v_add_f32_dpp v139, v139, v139 row_ror:8 row_mask:0xf bank_mask:0xf
    v_cvt_pk_bf16_f32 v140, v132, v133
    v_cvt_pk_bf16_f32 v141, v134, v135
    v_cvt_pk_bf16_f32 v142, v136, v137
    v_cvt_pk_bf16_f32 v143, v138, v139
    s_mov_b32 exec_lo, 0xf000f
    s_mov_b32 exec_hi, 0xf000f
    ds_write_b128 v15, v[140:143]
    s_mov_b64 exec, -1
    s_waitcnt lgkmcnt(0)
L_a_done:
    s_barrier
    s_cmp_lg_u32 s3, 0
    s_cbranch_scc1 L_a_pub
    ds_read_b128 v[140:143], v16
    s_waitcnt lgkmcnt(0)
    buffer_store_dwordx4 v[140:143], v20, s[12:15], s92 offen sc1
    v_bitop3_b32 v18, v140, v141, v142 bitop3:0x96
    v_xor_b32 v18, v143, v18
    s_nop 1
    v_xor_b32_dpp v18, v18, v18 quad_perm:[1,0,3,2] row_mask:0xf bank_mask:0xf
    s_nop 1
    v_xor_b32_dpp v18, v18, v18 quad_perm:[2,3,0,1] row_mask:0xf bank_mask:0xf
    s_nop 1
    v_xor_b32_dpp v18, v18, v18 row_ror:4 row_mask:0xf bank_mask:0xf
    s_nop 1
    v_xor_b32_dpp v18, v18, v18 row_ror:8 row_mask:0xf bank_mask:0xf
    v_xor_b32 v19, s56, v18
    s_mov_b32 exec_lo, 0xf000f
    s_mov_b32 exec_hi, 0xf000f
    buffer_store_dwordx2 v[18:19], v21, s[12:15], s93 offen sc1
    s_mov_b64 exec, -1
L_a_pub:
    s_cmp_lg_u32 s98, 7
    s_cbranch_scc1 L_norel
    s_waitcnt vmcnt(0)
    v_readfirstlane_b32 s1, v22
    s_nop 0
    s_and_b32 s1, s1, 31
    s_cmp_lg_u32 s1, 31
    s_nop 0
    s_cbranch_scc1 L_norel
    s_mov_b32 s1, 147456
    buffer_store_dword v31, v30, s[12:15], s1 offen sc1
    s_mov_b64 exec, -1
L_norel:
    s_cmp_lg_u32 s3, 5
    s_cbranch_scc1 L_noxt
    s_and_b32 s92, s2, 7
    s_lshl_b32 s92, s92, 11
    s_lshr_b32 s93, s2, 3
    s_lshl_b32 s93, s93, 7
    s_add_u32 s92, s92, s93
    s_add_u32 s92, s92, 245760
    v_mov_b32 v9, s52
    s_mov_b64 exec, 1
    buffer_store_dword v9, off, s[12:15], s92 sc1
    s_mov_b64 exec, -1
L_noxt:
    s_and_b32 s7, s2, 7
    s_lshr_b32 s63, s2, 3
    v_and_b32 v7, 1, v3
    v_lshl_add_u32 v6, v7, 18, v5
    v_lshrrev_b32 v7, 1, v3
    v_lshl_add_u32 v6, v7, 17, v6
    v_xor_b32 v7, 0x80, v6
    s_lshl_b32 s0, s5, 20
    s_add_u32 s0, s0, s6
    s_mov_b32 s61, 0
    s_and_b32 s94, s3, 3
    s_lshr_b32 s95, s3, 2
    v_bfe_u32 v56, v1, 2, 3
    v_lshlrev_b32 v56, 1, v56
    s_lshl_b32 s92, s94, 2
    v_bitop3_b32 v56, v56, v4, s92 bitop3:0x96
    v_lshlrev_b32 v56, 4, v56
    v_bfe_u32 v58, v1, 2, 2
    v_lshl_add_u32 v58, v3, 3, v58
    v_lshl_add_u32 v56, v58, 8, v56
    v_add_u32 v56, 98304, v56
    v_and_b32 v5, 31, v1
    v_lshlrev_b32 v5, 11, v5
    s_lshl_b32 s90, s94, 16
    s_lshl_b32 s91, s5, 9
    s_add_u32 s90, s90, s91
    s_lshl_b32 s91, s4, 4
    s_add_u32 s90, s90, s91
    s_add_u32 s90, s90, 5242880
    s_lshl_b32 s96, s4, 2
    s_add_u32 s96, s96, s5
    s_lshl_b32 s96, s96, 2
    s_add_u32 s96, s96, s94
    s_lshl_b32 s91, s96, 13
    s_lshl_b32 s93, s95, 12
    s_add_u32 s91, s91, s93
    s_add_u32 s91, s91, 1048576
    s_lshl_b32 s92, s95, 4
    v_lshlrev_b32 v48, 4, v11
    v_lshl_add_u32 v48, v3, 1, v48
    s_mul_i32 s93, s3, 272
    s_add_u32 s93, s93, 132096
    v_add_u32 v48, s93, v48
    v_and_b32 v49, 7, v1
    v_mul_u32_u24 v49, 272, v49
    v_lshl_add_u32 v49, v3, 4, v49
    v_add_u32 v49, 132096, v49
    v_lshlrev_b32 v50, 6, v3
    v_lshl_add_u32 v50, v4, 4, v50
    s_lshl_b32 s98, s4, 12
    s_lshl_b32 s93, s94, 10
    s_add_u32 s98, s98, s93
    s_lshl_b32 s93, s5, 8
    s_add_u32 s98, s98, s93
    s_add_u32 s98, s98, 262144
    v_add_u32 v51, s92, v3
    v_lshlrev_b32 v51, 2, v51
    v_cmp_eq_u32 s[88:89], s95, v3
    s_lshl_b32 s96, s94, 14
    s_and_b32 s93, s2, 31
    s_lshl_b32 s93, s93, 7
    s_add_u32 s96, s96, s93
    s_add_u32 s96, s96, 655360
    s_add_u32 s54, s12, s96
    s_addc_u32 s55, s13, 0
    s_mul_i32 s17, s7, 7
    s_mul_i32 s93, s7, 4
    s_add_u32 s93, s93, 12
    s_cmp_lt_u32 s7, 4
    s_cselect_b32 s16, 3357, 29
    s_cselect_b32 s17, s17, s93
    v_lshrrev_b32 v8, 2, v1
    s_cmp_lt_u32 s3, 4
    s_cbranch_scc1 L_wlo
    s_mov_b32 s61, 0
    v_bfe_u32 v59, v1, 2, 2
    v_lshl_add_u32 v59, v3, 3, v59
    v_lshlrev_b32 v58, 6, v59
    v_lshl_add_u32 v58, v4, 3, v58
    s_bitcmp1_b32 s16, s63
    s_cbranch_scc1 L_E1
    s_bitcmp1_b32 58082, s63
    s_cbranch_scc1 L_D1
L_wnone:
    s_barrier
    s_load_dword s97, s[54:55], 0 glc
    s_branch L_cstart
L_D1:
    s_mov_b32 s61, 2
    s_bfm_b32 s63, s63, 0
    s_and_b32 s63, s63, 58082
    s_bcnt1_i32_b32 s63, s63
    v_lshrrev_b32 v8, 3, v1
    v_lshlrev_b32 v8, 10, v8
    v_and_b32 v9, 7, v1
    v_lshl_add_u32 v8, v9, 4, v8
    s_lshl_b32 s99, s7, 19
    s_lshl_b32 s93, s94, 17
    s_add_u32 s99, s99, s93
    s_lshl_b32 s93, s63, 7
    s_add_u32 s99, s99, s93
    s_lshl_b32 s6, s94, 14
    s_mov_b32 m0, s6
    s_add_u32 s93, s99, 0
    buffer_load_dwordx4 v8, s[32:35], s93 offen nt lds
    s_add_u32 m0, m0, 1024
    s_add_u32 s93, s99, 8192
    buffer_load_dwordx4 v8, s[32:35], s93 offen nt lds
    s_add_u32 m0, m0, 1024
    s_add_u32 s93, s99, 16384
    buffer_load_dwordx4 v8, s[32:35], s93 offen nt lds
    s_add_u32 m0, m0, 1024
    s_add_u32 s93, s99, 24576
    s_waitcnt vmcnt(2)
    buffer_load_dwordx4 v8, s[32:35], s93 offen nt lds
    s_add_u32 m0, m0, 1024
    s_add_u32 s93, s99, 32768
    s_waitcnt vmcnt(2)
    buffer_load_dwordx4 v8, s[32:35], s93 offen nt lds
    s_add_u32 m0, m0, 1024
    s_add_u32 s93, s99, 40960
    s_waitcnt vmcnt(2)
    buffer_load_dwordx4 v8, s[32:35], s93 offen nt lds
    s_add_u32 m0, m0, 1024
    s_add_u32 s93, s99, 49152
    s_waitcnt vmcnt(2)
    buffer_load_dwordx4 v8, s[32:35], s93 offen nt lds
    s_add_u32 m0, m0, 1024
    s_add_u32 s93, s99, 57344
    s_waitcnt vmcnt(2)
    buffer_load_dwordx4 v8, s[32:35], s93 offen nt lds
    s_add_u32 m0, m0, 1024
    s_add_u32 s93, s99, 65536
    s_waitcnt vmcnt(2)
    buffer_load_dwordx4 v8, s[32:35], s93 offen nt lds
    s_add_u32 m0, m0, 1024
    s_add_u32 s93, s99, 73728
    s_waitcnt vmcnt(2)
    buffer_load_dwordx4 v8, s[32:35], s93 offen nt lds
    s_add_u32 m0, m0, 1024
    s_add_u32 s93, s99, 81920
    s_waitcnt vmcnt(2)
    buffer_load_dwordx4 v8, s[32:35], s93 offen nt lds
    s_add_u32 m0, m0, 1024
    s_add_u32 s93, s99, 90112
    s_waitcnt vmcnt(2)
    buffer_load_dwordx4 v8, s[32:35], s93 offen nt lds
    s_add_u32 m0, m0, 1024
    s_add_u32 s93, s99, 98304
    s_waitcnt vmcnt(2)
    buffer_load_dwordx4 v8, s[32:35], s93 offen nt lds
    s_add_u32 m0, m0, 1024
    s_add_u32 s93, s99, 106496
    s_waitcnt vmcnt(2)
    buffer_load_dwordx4 v8, s[32:35], s93 offen nt lds
    s_add_u32 m0, m0, 1024
    s_add_u32 s93, s99, 114688
    s_waitcnt vmcnt(2)
    buffer_load_dwordx4 v8, s[32:35], s93 offen nt lds
    s_add_u32 m0, m0, 1024
    s_add_u32 s93, s99, 122880
    s_waitcnt vmcnt(2)
    buffer_load_dwordx4 v8, s[32:35], s93 offen nt lds
    v_lshlrev_b32 v57, 7, v59
    v_lshl_add_u32 v57, v4, 3, v57
    v_add_u32 v57, s6, v57
    v_bfe_u32 v128, v1, 2, 2
    v_lshlrev_b32 v128, 8, v128
    v_lshl_add_u32 v128, v3, 6, v128
    v_lshl_add_u32 v128, v4, 4, v128
    v_lshlrev_b32 v129, 8, v4
    v_bfe_u32 v9, v1, 2, 2
    v_lshl_add_u32 v129, v9, 6, v129
    v_lshl_add_u32 v129, v3, 4, v129
    s_lshl_b32 s93, s94, 10
    s_add_u32 s93, s93, 139264
    v_add_u32 v129, s93, v129
    v_bfe_u32 v130, v1, 1, 2
    v_lshlrev_b32 v130, 8, v130
    v_lshrrev_b32 v9, 3, v1
    v_lshl_add_u32 v130, v9, 5, v130
    v_and_b32 v9, 1, v1
    v_lshl_add_u32 v130, v9, 4, v130
    v_add_u32 v130, 139264, v130
    v_lshlrev_b32 v131, 3, v1
    s_lshl_b32 s6, s7, 14
    s_lshl_b32 s93, s94, 12
    s_add_u32 s6, s6, s93
    s_add_u32 s6, s6, 262144
    s_lshl_b32 s99, s7, 12
    s_lshl_b32 s93, s63, 9
    s_add_u32 s99, s99, s93
    s_add_u32 s99, s99, 393216
    s_lshl_b32 s93, s7, 11
    s_add_u32 s93, s93, 245760
    v_lshlrev_b32 v9, 7, v11
    buffer_load_dword v10, v9, s[12:15], s93 offen sc1
    buffer_load_dwordx4 v[16:19], v128, s[12:15], s6 offen offset:0 sc1
    buffer_load_dwordx4 v[20:23], v128, s[12:15], s6 offen offset:1024 sc1
    buffer_load_dwordx4 v[24:27], v128, s[12:15], s6 offen offset:2048 sc1
    buffer_load_dwordx4 v[28:31], v128, s[12:15], s6 offen offset:3072 sc1
    s_waitcnt vmcnt(0)
    v_cmp_ne_u32 vcc, s52, v10
    s_nop 0
    s_cmp_eq_u64 vcc, 0
    s_cselect_b32 s53, 1, 0
    ds_read_b64_tr_b16 v[64:65], v57 offset:0
    ds_read_b64_tr_b16 v[66:67], v57 offset:512
    ds_read_b64_tr_b16 v[68:69], v57 offset:32
    ds_read_b64_tr_b16 v[70:71], v57 offset:544
    ds_read_b64_tr_b16 v[72:73], v57 offset:64
    ds_read_b64_tr_b16 v[74:75], v57 offset:576
    ds_read_b64_tr_b16 v[76:77], v57 offset:96
    ds_read_b64_tr_b16 v[78:79], v57 offset:608
    s_waitcnt lgkmcnt(4)
    ds_read_b64_tr_b16 v[80:81], v57 offset:4096
    ds_read_b64_tr_b16 v[82:83], v57 offset:4608
    ds_read_b64_tr_b16 v[84:85], v57 offset:4128
    ds_read_b64_tr_b16 v[86:87], v57 offset:4640
    ds_read_b64_tr_b16 v[88:89], v57 offset:4160
    ds_read_b64_tr_b16 v[90:91], v57 offset:4672
    ds_read_b64_tr_b16 v[92:93], v57 offset:4192
    ds_read_b64_tr_b16 v[94:95], v57 offset:4704
    s_waitcnt lgkmcnt(4)
    ds_read_b64_tr_b16 v[96:97], v57 offset:8192
    ds_read_b64_tr_b16 v[98:99], v57 offset:8704
    ds_read_b64_tr_b16 v[100:101], v57 offset:8224
    ds_read_b64_tr_b16 v[102:103], v57 offset:8736
    ds_read_b64_tr_b16 v[104:105], v57 offset:8256
    ds_read_b64_tr_b16 v[106:107], v57 offset:8768
    ds_read_b64_tr_b16 v[108:109], v57 offset:8288
    ds_read_b64_tr_b16 v[110:111], v57 offset:8800
    s_waitcnt lgkmcnt(4)
    ds_read_b64_tr_b16 v[112:113], v57 offset:12288
    ds_read_b64_tr_b16 v[114:115], v57 offset:12800
    ds_read_b64_tr_b16 v[116:117], v57 offset:12320
    ds_read_b64_tr_b16 v[118:119], v57 offset:12832
    ds_read_b64_tr_b16 v[120:121], v57 offset:12352
    ds_read_b64_tr_b16 v[122:123], v57 offset:12864
    ds_read_b64_tr_b16 v[124:125], v57 offset:12384
    ds_read_b64_tr_b16 v[126:127], v57 offset:12896
    s_waitcnt lgkmcnt(4)
    s_branch L_wnone
L_E1:
    s_bfm_b32 s63, s63, 0
    s_and_b32 s63, s63, s16
    s_bcnt1_i32_b32 s63, s63
    s_add_u32 s63, s63, s17
    s_cmp_ge_u32 s63, 43
    s_cbranch_scc1 L_wnone
    s_mov_b32 s61, 1
    v_mul_u32_u24 v8, 2752, v8
    v_lshl_add_u32 v8, v4, 4, v8
    s_mul_i32 s99, s94, 352256
    s_lshl_b32 s93, s63, 6
    s_add_u32 s99, s99, s93
    s_lshl_b32 s6, s94, 14
    s_mov_b32 m0, s6
    v_bfe_u32 v9, v1, 2, 2
    v_lshlrev_b32 v9, 6, v9
    v_lshl_add_u32 v9, v4, 10, v9
    v_lshl_add_u32 v9, v3, 4, v9
    s_lshl_b32 s93, s94, 8
    buffer_load_dwordx4 v[128:131], v9, s[8:11], s93 offen
    s_add_u32 s93, s99, 0
    s_waitcnt vmcnt(1)
    buffer_load_dwordx4 v8, s[36:39], s93 offen nt lds
    s_add_u32 m0, m0, 1024
    s_add_u32 s93, s99, 44032
    s_waitcnt vmcnt(1)
    buffer_load_dwordx4 v8, s[36:39], s93 offen nt lds
    s_add_u32 m0, m0, 1024
    s_add_u32 s93, s99, 88064
    s_waitcnt vmcnt(3)
    buffer_load_dwordx4 v8, s[36:39], s93 offen nt lds
    s_add_u32 m0, m0, 1024
    s_add_u32 s93, s99, 132096
    s_waitcnt vmcnt(3)
    buffer_load_dwordx4 v8, s[36:39], s93 offen nt lds
    s_add_u32 m0, m0, 1024
    s_add_u32 s93, s99, 176128
    s_waitcnt vmcnt(3)
    buffer_load_dwordx4 v8, s[36:39], s93 offen nt lds
    s_add_u32 m0, m0, 1024
    s_add_u32 s93, s99, 220160
    s_waitcnt vmcnt(3)
    buffer_load_dwordx4 v8, s[36:39], s93 offen nt lds
    s_add_u32 m0, m0, 1024
    s_add_u32 s93, s99, 264192
    s_waitcnt vmcnt(3)
    buffer_load_dwordx4 v8, s[36:39], s93 offen nt lds
    s_add_u32 m0, m0, 1024
    s_add_u32 s93, s99, 308224
    s_waitcnt vmcnt(3)
    buffer_load_dwordx4 v8, s[36:39], s93 offen nt lds
    s_add_u32 m0, m0, 1024
    s_add_u32 s93, s99, 0
    s_waitcnt vmcnt(3)
    buffer_load_dwordx4 v8, s[40:43], s93 offen nt lds
    s_add_u32 m0, m0, 1024
    s_add_u32 s93, s99, 44032
    s_waitcnt vmcnt(3)
    buffer_load_dwordx4 v8, s[40:43], s93 offen nt lds
    s_add_u32 m0, m0, 1024
    s_add_u32 s93, s99, 88064
    s_waitcnt vmcnt(3)
    buffer_load_dwordx4 v8, s[40:43], s93 offen nt lds
    s_add_u32 m0, m0, 1024
    s_add_u32 s93, s99, 132096
    s_waitcnt vmcnt(3)
    buffer_load_dwordx4 v8, s[40:43], s93 offen nt lds
    s_add_u32 m0, m0, 1024
    s_add_u32 s93, s99, 176128
    s_waitcnt vmcnt(3)
    buffer_load_dwordx4 v8, s[40:43], s93 offen nt lds
    s_add_u32 m0, m0, 1024
    s_add_u32 s93, s99, 220160
    s_waitcnt vmcnt(3)
    buffer_load_dwordx4 v8, s[40:43], s93 offen nt lds
    s_add_u32 m0, m0, 1024
    s_add_u32 s93, s99, 264192
    s_waitcnt vmcnt(3)
    buffer_load_dwordx4 v8, s[40:43], s93 offen nt lds
    s_add_u32 m0, m0, 1024
    s_add_u32 s93, s99, 308224
    s_waitcnt vmcnt(3)
    buffer_load_dwordx4 v8, s[40:43], s93 offen nt lds
    s_add_u32 m0, m0, 1024
    v_and_b32 v8, 0xff, v6
    v_lshl_add_u32 v8, v3, 10, v8
    v_xor_b32 v9, 0x80, v8
    s_lshl_b32 s99, s63, 15
    s_lshl_b32 s93, s94, 8
    s_add_u32 s99, s99, s93
    s_lshl_b32 s98, s94, 13
    s_add_u32 s98, s98, 65536
    s_mov_b32 m0, s98
    s_add_u32 s93, s99, 0
    s_waitcnt vmcnt(3)
    buffer_load_dwordx4 v8, s[44:47], s93 offen nt lds
    s_add_u32 m0, m0, 1024
    s_add_u32 s93, s99, 4096
    s_waitcnt vmcnt(3)
    buffer_load_dwordx4 v8, s[44:47], s93 offen nt lds
    s_add_u32 m0, m0, 1024
    s_add_u32 s93, s99, 8192
    s_waitcnt vmcnt(3)
    buffer_load_dwordx4 v9, s[44:47], s93 offen nt lds
    s_add_u32 m0, m0, 1024
    s_add_u32 s93, s99, 12288
    s_waitcnt vmcnt(3)
    buffer_load_dwordx4 v9, s[44:47], s93 offen nt lds
    s_add_u32 m0, m0, 1024
    s_add_u32 s93, s99, 16384
    s_waitcnt vmcnt(3)
    buffer_load_dwordx4 v8, s[44:47], s93 offen nt lds
    s_add_u32 m0, m0, 1024
    s_add_u32 s93, s99, 20480
    s_waitcnt vmcnt(3)
    buffer_load_dwordx4 v8, s[44:47], s93 offen nt lds
    s_add_u32 m0, m0, 1024
    s_add_u32 s93, s99, 24576
    s_waitcnt vmcnt(3)
    buffer_load_dwordx4 v9, s[44:47], s93 offen nt lds
    s_add_u32 m0, m0, 1024
    s_add_u32 s93, s99, 28672
    s_waitcnt vmcnt(3)
    buffer_load_dwordx4 v9, s[44:47], s93 offen nt lds
    s_add_u32 m0, m0, 1024
    v_bfe_u32 v57, v1, 2, 3
    v_lshlrev_b32 v57, 1, v57
    v_xor_b32 v57, v57, v4
    v_lshlrev_b32 v57, 4, v57
    v_lshl_add_u32 v57, v59, 8, v57
    v_add_u32 v57, s98, v57
    v_lshlrev_b32 v188, 6, v4
    v_lshl_add_u32 v188, v3, 4, v188
    v_add_u32 v188, 138240, v188
    v_bfe_u32 v9, v1, 1, 1
    v_mul_u32_u24 v189, 6144, v9
    v_and_b32 v9, 1, v1
    v_lshl_add_u32 v189, v9, 6, v189
    v_lshl_add_u32 v189, v3, 4, v189
    s_lshl_b32 s93, s94, 10
    s_add_u32 s93, s93, 139264
    v_add_u32 v190, s93, v2
    v_cmp_lt_u32 vcc, 23, v1
    v_mov_b32 v9, 0x7fffff00
    s_nop 0
    v_cndmask_b32 v191, v2, v9, vcc
    s_and_b32 s93, s63, 1
    s_lshl_b32 s93, s93, 1
    v_bfe_u32 v9, v1, 2, 1
    v_add_u32 v9, s93, v9
    v_lshlrev_b32 v224, 8, v4
    v_lshl_add_u32 v224, v9, 4, v224
    s_lshr_b32 s93, s63, 3
    s_lshl_b32 s93, s93, 10
    s_bfe_u32 s96, s63, 0x20001
    s_lshl_b32 s96, s96, 6
    s_add_u32 s93, s93, s96
    s_add_u32 s93, s93, 139264
    v_add_u32 v224, s93, v224
    v_lshlrev_b32 v225, 10, v9
    v_lshl_add_u32 v225, v4, 4, v225
    v_lshl_add_u32 v225, v3, 1, v225
    v_add_u32 v58, s6, v58
    v_lshlrev_b32 v180, 8, v4
    v_lshl_add_u32 v180, v3, 4, v180
    v_add_u32 v180, s6, v180
    v_lshlrev_b32 v181, 3, v4
    v_lshl_add_u32 v181, v3, 2, v181
    v_add_u32 v181, s6, v181
    s_and_b32 s93, s3, 1
    s_lshl_b32 s93, s93, 6
    v_add_u32 v184, s93, v1
    v_lshrrev_b32 v183, 5, v184
    v_and_b32 v182, 31, v184
    v_lshlrev_b32 v182, 2, v182
    v_lshl_add_u32 v182, v183, 8, v182
    v_lshlrev_b32 v183, 3, v183
    v_lshlrev_b32 v184, 1, v184
    v_add_u32 v184, 138240, v184
    v_bfe_u32 v185, v1, 2, 2
    v_lshlrev_b32 v185, 8, v185
    v_lshl_add_u32 v185, v3, 6, v185
    v_lshl_add_u32 v185, v4, 4, v185
    v_mov_b32 v148, s57
    v_mov_b32 v149, s57
    v_mov_b32 v150, s57
    v_mov_b32 v151, s57
    v_mov_b32 v226, v57
    v_mov_b32 v227, v58
    s_nop 0
    s_branch L_wnone
L_wlo:
    s_lshr_b32 s93, s3, 1
    s_lshl_b32 s93, s93, 19
    s_add_u32 s0, s0, s93
    s_and_b32 s93, s3, 1
    s_lshl_b32 s93, s93, 16
    s_add_u32 s0, s0, s93
    s_lshl_b32 s93, s3, 13
    s_add_u32 m0, s93, 98304
    s_lshl_b32 s96, s2, 7
    s_add_u32 s96, s96, 163840
    s_mov_b64 exec, 1
    s_mov_b32 s60, 200000
poll_2:
    buffer_load_dword v9, off, s[12:15], s96 sc1
    s_waitcnt vmcnt(0)
    v_cmp_ne_u32 vcc, s56, v9
    s_nop 3
    s_cbranch_vccz pdone_3
    s_sleep 3
    s_sub_u32 s60, s60, 1
    s_cbranch_scc0 poll_2
pdone_3:
    s_mov_b64 exec, -1
L_nogw:
    s_add_u32 s93, s0, 0
    buffer_load_dwordx4 v6, s[28:31], s93 offen nt lds
    s_add_u32 m0, m0, 1024
    s_add_u32 s93, s0, 8192
    buffer_load_dwordx4 v6, s[28:31], s93 offen nt lds
    s_add_u32 m0, m0, 1024
    s_add_u32 s93, s0, 16384
    buffer_load_dwordx4 v7, s[28:31], s93 offen nt lds
    s_add_u32 m0, m0, 1024
    s_add_u32 s93, s0, 24576
    buffer_load_dwordx4 v7, s[28:31], s93 offen nt lds
    s_add_u32 m0, m0, 1024
    s_add_u32 s93, s0, 32768
    buffer_load_dwordx4 v6, s[28:31], s93 offen nt lds
    s_add_u32 m0, m0, 1024
    s_add_u32 s93, s0, 40960
    buffer_load_dwordx4 v6, s[28:31], s93 offen nt lds
    s_add_u32 m0, m0, 1024
    s_add_u32 s93, s0, 49152
    buffer_load_dwordx4 v7, s[28:31], s93 offen nt lds
    s_add_u32 m0, m0, 1024
    s_add_u32 s93, s0, 57344
    buffer_load_dwordx4 v7, s[28:31], s93 offen nt lds
    s_waitcnt vmcnt(0)
    s_load_dword s97, s[54:55], 0 glc
    s_barrier
    s_lshl_b32 s93, s7, 11
    s_add_u32 s93, s93, 245760
    v_lshlrev_b32 v9, 7, v11
    buffer_load_dword v60, v9, s[12:15], s93 offen sc1
    ds_read_b64_tr_b16 v[64:65], v56 offset:0
    ds_read_b64_tr_b16 v[66:67], v56 offset:1024
    ds_read_b64_tr_b16 v[68:69], v56 offset:8
    ds_read_b64_tr_b16 v[70:71], v56 offset:1032
    s_waitcnt lgkmcnt(4)
    ds_read_b64_tr_b16 v[72:73], v56 offset:8192
    ds_read_b64_tr_b16 v[74:75], v56 offset:9216
    ds_read_b64_tr_b16 v[76:77], v56 offset:8200
    ds_read_b64_tr_b16 v[78:79], v56 offset:9224
    s_waitcnt lgkmcnt(4)
    ds_read_b64_tr_b16 v[80:81], v56 offset:16384
    ds_read_b64_tr_b16 v[82:83], v56 offset:17408
    ds_read_b64_tr_b16 v[84:85], v56 offset:16392
    ds_read_b64_tr_b16 v[86:87], v56 offset:17416
    s_waitcnt lgkmcnt(4)
    ds_read_b64_tr_b16 v[88:89], v56 offset:24576
    ds_read_b64_tr_b16 v[90:91], v56 offset:25600
    ds_read_b64_tr_b16 v[92:93], v56 offset:24584
    ds_read_b64_tr_b16 v[94:95], v56 offset:25608
    s_waitcnt lgkmcnt(4)
    s_setprio 2
L_cstart:
    v_mov_b32 v52, -1
    s_lshl_b32 s93, s94, 2
    s_add_u32 s93, s93, 131072
    v_mov_b32 v59, s93
    v_mov_b32 v58, s56
    s_waitcnt lgkmcnt(0)
    s_cmp_eq_u32 s97, s56
    s_cbranch_scc1 L_ofgo
    v_lshrrev_b32 v9, 4, v5
    s_lshl_b32 s96, s94, 12
    s_lshl_b32 s93, s4, 2
    s_add_u32 s96, s96, s93
    s_add_u32 s96, s96, 229376
    buffer_load_dword v52, v9, s[12:15], s96 offen sc1
    s_waitcnt vmcnt(0)
    v_xor_b32 v52, s56, v52
    v_mov_b32 v54, v52
    s_nop 1
    v_max_f32_dpp v54, v54, v54 quad_perm:[1,0,3,2] row_mask:0xf bank_mask:0xf
    s_nop 1
    v_max_f32_dpp v54, v54, v54 quad_perm:[2,3,0,1] row_mask:0xf bank_mask:0xf
    s_nop 1
    v_max_f32_dpp v54, v54, v54 row_ror:4 row_mask:0xf bank_mask:0xf
    s_nop 1
    v_max_f32_dpp v54, v54, v54 row_ror:8 row_mask:0xf bank_mask:0xf
    v_mov_b32 v55, v54
    s_nop 1
    v_permlane16_swap_b32 v54, v55
    v_max_f32 v54, v54, v55
    v_sub_f32 v53, v52, v54
    v_exp_f32 v53, v53
    s_nop 0
    v_cvt_pk_bf16_f32 v54, v53, 0
    v_lshlrev_b32 v53, 16, v54
    ds_bpermute_b32 v32, v51, v54 offset:0
    ds_bpermute_b32 v33, v51, v54 offset:16
    ds_bpermute_b32 v34, v51, v54 offset:32
    ds_bpermute_b32 v35, v51, v54 offset:48
    s_waitcnt lgkmcnt(0)
    v_lshlrev_b32 v36, 16, v32
    v_lshlrev_b32 v37, 16, v33
    v_lshlrev_b32 v38, 16, v34
    v_lshlrev_b32 v39, 16, v35
    s_mov_b32 s60, 200000
L_of:
    s_load_dword s96, s[54:55], 0 glc
    s_waitcnt lgkmcnt(0)
    s_cmp_eq_u32 s96, s56
    s_cbranch_scc1 L_ofgo
    s_sub_u32 s60, s60, 1
    s_cbranch_scc0 L_of
L_ofgo:
    s_mov_b32 s60, 200000
L_call:
    buffer_load_dwordx4 v[12:15], v5, s[12:15], s90 offen sc1
    buffer_load_dwordx4 v[16:19], v2, s[12:15], s91 offen offset:0 sc1
    buffer_load_dwordx4 v[20:23], v2, s[12:15], s91 offen offset:1024 sc1
    buffer_load_dwordx4 v[24:27], v2, s[12:15], s91 offen offset:2048 sc1
    buffer_load_dwordx4 v[28:31], v2, s[12:15], s91 offen offset:3072 sc1
    s_sub_u32 s60, s60, 1
    s_cbranch_scc1 L_cdone
    s_waitcnt vmcnt(4)
    v_cmp_ne_u32 vcc, v12, v52
    v_bitop3_b32 v10, v12, v13, v14 bitop3:0x96
    v_bitop3_b32 v10, v10, v15, s56 bitop3:0x96
    v_cndmask_b32 v9, 0, v14, s[88:89]
    s_nop 0
    s_cbranch_vccnz L_cnewm
L_crec:
    v_mul_f32 v14, v53, v13
    s_waitcnt vmcnt(3)
    v_bitop3_b32 v9, v9, v16, v17 bitop3:0x96
    v_bitop3_b32 v9, v9, v18, v19 bitop3:0x96
    v_dot2_f32_bf16 v40, v16, v32, 0
    v_dot2_f32_bf16 v41, v16, v36, 0
    v_add_f32_dpp v14, v14, v14 quad_perm:[1,0,3,2] row_mask:0xf bank_mask:0xf
    v_dot2_f32_bf16 v42, v17, v32, 0
    v_dot2_f32_bf16 v43, v17, v36, 0
    v_add_f32_dpp v14, v14, v14 quad_perm:[2,3,0,1] row_mask:0xf bank_mask:0xf
    v_dot2_f32_bf16 v44, v18, v32, 0
    v_dot2_f32_bf16 v45, v18, v36, 0
    v_add_f32_dpp v14, v14, v14 row_ror:4 row_mask:0xf bank_mask:0xf
    v_dot2_f32_bf16 v46, v19, v32, 0
    v_dot2_f32_bf16 v47, v19, v36, 0
    v_add_f32_dpp v14, v14, v14 row_ror:8 row_mask:0xf bank_mask:0xf
    s_waitcnt vmcnt(2)
    v_bitop3_b32 v9, v9, v20, v21 bitop3:0x96
    v_bitop3_b32 v9, v9, v22, v23 bitop3:0x96
    v_dot2_f32_bf16 v40, v20, v33, v40
    v_dot2_f32_bf16 v41, v20, v37, v41
    v_mov_b32 v15, v14
    v_dot2_f32_bf16 v42, v21, v33, v42
    v_dot2_f32_bf16 v43, v21, v37, v43
    v_permlane16_swap_b32 v14, v15
    v_dot2_f32_bf16 v44, v22, v33, v44
    v_dot2_f32_bf16 v45, v22, v37, v45
    v_add_f32 v14, v14, v15
    v_dot2_f32_bf16 v46, v23, v33, v46
    v_dot2_f32_bf16 v47, v23, v37, v47
    v_rcp_f32 v14, v14
    s_waitcnt vmcnt(1)
    v_bitop3_b32 v9, v9, v24, v25 bitop3:0x96
    v_bitop3_b32 v9, v9, v26, v27 bitop3:0x96
    v_dot2_f32_bf16 v40, v24, v34, v40
    v_dot2_f32_bf16 v41, v24, v38, v41
    v_dot2_f32_bf16 v42, v25, v34, v42
    v_dot2_f32_bf16 v43, v25, v38, v43
    v_dot2_f32_bf16 v44, v26, v34, v44
    v_dot2_f32_bf16 v45, v26, v38, v45
    v_dot2_f32_bf16 v46, v27, v34, v46
    v_dot2_f32_bf16 v47, v27, v38, v47
    s_waitcnt vmcnt(0)
    v_bitop3_b32 v9, v9, v28, v29 bitop3:0x96
    v_bitop3_b32 v9, v9, v30, v31 bitop3:0x96
    v_dot2_f32_bf16 v40, v28, v35, v40
    v_dot2_f32_bf16 v41, v28, v39, v41
    v_xor_b32_dpp v9, v9, v9 quad_perm:[1,0,3,2] row_mask:0xf bank_mask:0xf
    v_dot2_f32_bf16 v42, v29, v35, v42
    v_dot2_f32_bf16 v43, v29, v39, v43
    v_xor_b32_dpp v9, v9, v9 quad_perm:[2,3,0,1] row_mask:0xf bank_mask:0xf
    v_dot2_f32_bf16 v44, v30, v35, v44
    v_dot2_f32_bf16 v45, v30, v39, v45
    v_xor_b32_dpp v9, v9, v9 row_ror:4 row_mask:0xf bank_mask:0xf
    v_dot2_f32_bf16 v46, v31, v35, v46
    v_dot2_f32_bf16 v47, v31, v39, v47
    v_xor_b32_dpp v9, v9, v9 row_ror:8 row_mask:0xf bank_mask:0xf
    v_mov_b32 v15, v9
    v_permlane16_swap_b32 v40, v41
    v_permlane16_swap_b32 v42, v43
    v_permlane16_swap_b32 v9, v15
    v_xor_b32 v9, v9, v15
    v_mov_b32 v15, v9
    v_permlane16_swap_b32 v44, v45
    v_permlane16_swap_b32 v46, v47
    v_permlane32_swap_b32 v9, v15
    v_bitop3_b32 v9, v9, v15, v10 bitop3:0xbe
    v_cmp_ne_u32 vcc, 0, v9
L_cdone:
    v_add_f32 v40, v40, v41
    v_add_f32 v42, v42, v43
    v_add_f32 v44, v44, v45
    v_add_f32 v46, v46, v47
    v_permlane32_swap_b32 v40, v42
    s_nop 0
    v_permlane32_swap_b32 v44, v46
    v_add_f32 v40, v40, v42
    v_add_f32 v44, v44, v46
    s_cbranch_vccnz L_cagain
L_cok:
    v_mul_f32 v40, v40, v14
    v_mul_f32 v44, v44, v14
    v_cvt_pk_bf16_f32 v40, v40, v44
    ds_write_b16 v48, v40
    ds_write_b16_d16_hi v48, v40 offset:8
    s_waitcnt lgkmcnt(0)
    s_barrier
    s_cmp_ge_u32 s3, 4
    s_cbranch_scc1 L_hi
    v_cmp_ne_u32 vcc, s52, v60
    ds_read_b128 v[16:19], v49 offset:0
    ds_read_b128 v[20:23], v49 offset:64
    ds_read_b128 v[24:27], v49 offset:128
    ds_read_b128 v[28:31], v49 offset:192
    s_waitcnt lgkmcnt(3)
    v_mfma_f32_16x16x32_bf16 v[40:43], v[64:67], v[16:19], 0
    v_mfma_f32_16x16x32_bf16 v[44:47], v[68:71], v[16:19], 0
    s_waitcnt lgkmcnt(2)
    v_mfma_f32_16x16x32_bf16 v[40:43], v[72:75], v[20:23], v[40:43]
    v_mfma_f32_16x16x32_bf16 v[44:47], v[76:79], v[20:23], v[44:47]
    s_waitcnt lgkmcnt(1)
    v_mfma_f32_16x16x32_bf16 v[40:43], v[80:83], v[24:27], v[40:43]
    v_mfma_f32_16x16x32_bf16 v[44:47], v[84:87], v[24:27], v[44:47]
    s_waitcnt lgkmcnt(0)
    v_mfma_f32_16x16x32_bf16 v[40:43], v[88:91], v[28:31], v[40:43]
    v_mfma_f32_16x16x32_bf16 v[44:47], v[92:95], v[28:31], v[44:47]
    s_nop 6
    v_add_f32_dpp v40, v40, v40 row_ror:4 row_mask:0xf bank_mask:0xf
    v_add_f32_dpp v41, v41, v41 row_ror:4 row_mask:0xf bank_mask:0xf
    v_add_f32_dpp v42, v42, v42 row_ror:4 row_mask:0xf bank_mask:0xf
    v_add_f32_dpp v43, v43, v43 row_ror:4 row_mask:0xf bank_mask:0xf
    v_add_f32_dpp v44, v44, v44 row_ror:4 row_mask:0xf bank_mask:0xf
    v_add_f32_dpp v45, v45, v45 row_ror:4 row_mask:0xf bank_mask:0xf
    v_add_f32_dpp v46, v46, v46 row_ror:4 row_mask:0xf bank_mask:0xf
    v_add_f32_dpp v47, v47, v47 row_ror:4 row_mask:0xf bank_mask:0xf
    v_cvt_pk_bf16_f32 v12, v40, v41
    v_cvt_pk_bf16_f32 v13, v42, v43
    v_cvt_pk_bf16_f32 v14, v44, v45
    v_cvt_pk_bf16_f32 v15, v46, v47
    s_mov_b32 s60, 200000
    s_mov_b32 exec_lo, 0xf000f
    s_mov_b32 exec_hi, 0xf000f
    s_cbranch_vccnz L_cfar
    buffer_store_dwordx4 v[12:15], v50, s[12:15], s98 offen
    s_branch L_cst
L_cfar:
    buffer_store_dwordx4 v[12:15], v50, s[12:15], s98 offen sc1
L_cst:
    s_mov_b64 exec, -1
    s_endpgm
L_cnewm:
    v_mov_b32 v52, v12
    v_mov_b32 v54, v52
    s_nop 1
    v_max_f32_dpp v54, v54, v54 quad_perm:[1,0,3,2] row_mask:0xf bank_mask:0xf
    s_nop 1
    v_max_f32_dpp v54, v54, v54 quad_perm:[2,3,0,1] row_mask:0xf bank_mask:0xf
    s_nop 1
    v_max_f32_dpp v54, v54, v54 row_ror:4 row_mask:0xf bank_mask:0xf
    s_nop 1
    v_max_f32_dpp v54, v54, v54 row_ror:8 row_mask:0xf bank_mask:0xf
    v_mov_b32 v55, v54
    s_nop 1
    v_permlane16_swap_b32 v54, v55
    v_max_f32 v54, v54, v55
    v_sub_f32 v53, v52, v54
    v_exp_f32 v53, v53
    s_nop 0
    v_cvt_pk_bf16_f32 v54, v53, 0
    v_lshlrev_b32 v53, 16, v54
    ds_bpermute_b32 v32, v51, v54 offset:0
    ds_bpermute_b32 v33, v51, v54 offset:16
    ds_bpermute_b32 v34, v51, v54 offset:32
    ds_bpermute_b32 v35, v51, v54 offset:48
    s_waitcnt lgkmcnt(0)
    v_lshlrev_b32 v36, 16, v32
    v_lshlrev_b32 v37, 16, v33
    v_lshlrev_b32 v38, 16, v34
    v_lshlrev_b32 v39, 16, v35
    s_nop 0
    s_branch L_crec
L_cagain:
    s_cmp_lt_i32 s60, 0
    s_cbranch_scc1 L_cok
    s_branch L_call
L_hi:
    s_cmp_eq_u32 s61, 0
    s_cbranch_scc1 L_end
    s_cmp_eq_u32 s61, 1
    s_cbranch_scc1 L_E2
    s_lshl_b32 s98, s7, 7
    s_add_u32 s98, s98, 180224
    v_mov_b32 v132, s56
    s_mov_b32 s60, 200000
    s_barrier
L_dre:
    buffer_load_dwordx4 v[16:19], v128, s[12:15], s6 offen offset:0 sc1
    buffer_load_dwordx4 v[20:23], v128, s[12:15], s6 offen offset:1024 sc1
    buffer_load_dwordx4 v[24:27], v128, s[12:15], s6 offen offset:2048 sc1
    buffer_load_dwordx4 v[28:31], v128, s[12:15], s6 offen offset:3072 sc1
    s_waitcnt vmcnt(3)
    v_mfma_f32_16x16x32_bf16 v[144:147], v[64:67], v[16:19], 0
    v_mfma_f32_16x16x32_bf16 v[148:151], v[68:71], v[16:19], 0
    v_mfma_f32_16x16x32_bf16 v[152:155], v[72:75], v[16:19], 0
    v_mfma_f32_16x16x32_bf16 v[156:159], v[76:79], v[16:19], 0
    s_waitcnt vmcnt(2)
    v_mfma_f32_16x16x32_bf16 v[144:147], v[80:83], v[20:23], v[144:147]
    v_mfma_f32_16x16x32_bf16 v[148:151], v[84:87], v[20:23], v[148:151]
    v_mfma_f32_16x16x32_bf16 v[152:155], v[88:91], v[20:23], v[152:155]
    v_mfma_f32_16x16x32_bf16 v[156:159], v[92:95], v[20:23], v[156:159]
    s_waitcnt vmcnt(1)
    v_mfma_f32_16x16x32_bf16 v[144:147], v[96:99], v[24:27], v[144:147]
    v_mfma_f32_16x16x32_bf16 v[148:151], v[100:103], v[24:27], v[148:151]
    v_mfma_f32_16x16x32_bf16 v[152:155], v[104:107], v[24:27], v[152:155]
    v_mfma_f32_16x16x32_bf16 v[156:159], v[108:111], v[24:27], v[156:159]
    s_waitcnt vmcnt(0)
    v_mfma_f32_16x16x32_bf16 v[144:147], v[112:115], v[28:31], v[144:147]
    v_mfma_f32_16x16x32_bf16 v[148:151], v[116:119], v[28:31], v[148:151]
    v_mfma_f32_16x16x32_bf16 v[152:155], v[120:123], v[28:31], v[152:155]
    v_mfma_f32_16x16x32_bf16 v[156:159], v[124:127], v[28:31], v[156:159]
    s_nop 4
    v_cmp_u_f32 vcc, v144, v144
    v_add_f32_dpp v144, v144, v144 row_ror:8 row_mask:0xf bank_mask:0x3
    v_add_f32_dpp v145, v145, v145 row_ror:8 row_mask:0xf bank_mask:0x3
    v_add_f32_dpp v146, v146, v146 row_ror:8 row_mask:0xf bank_mask:0x3
    v_add_f32_dpp v147, v147, v147 row_ror:8 row_mask:0xf bank_mask:0x3
    s_cbranch_vccnz L_dnan
L_dok:
    v_add_f32_dpp v148, v148, v148 row_ror:8 row_mask:0xf bank_mask:0x3
    v_add_f32_dpp v149, v149, v149 row_ror:8 row_mask:0xf bank_mask:0x3
    v_add_f32_dpp v150, v150, v150 row_ror:8 row_mask:0xf bank_mask:0x3
    v_add_f32_dpp v151, v151, v151 row_ror:8 row_mask:0xf bank_mask:0x3
    v_add_f32_dpp v144, v152, v152 row_ror:8 row_mask:0xf bank_mask:0xc
    v_add_f32_dpp v145, v153, v153 row_ror:8 row_mask:0xf bank_mask:0xc
    v_add_f32_dpp v146, v154, v154 row_ror:8 row_mask:0xf bank_mask:0xc
    v_add_f32_dpp v147, v155, v155 row_ror:8 row_mask:0xf bank_mask:0xc
    v_add_f32_dpp v148, v156, v156 row_ror:8 row_mask:0xf bank_mask:0xc
    v_add_f32_dpp v149, v157, v157 row_ror:8 row_mask:0xf bank_mask:0xc
    v_add_f32_dpp v150, v158, v158 row_ror:8 row_mask:0xf bank_mask:0xc
    v_add_f32_dpp v151, v159, v159 row_ror:8 row_mask:0xf bank_mask:0xc
    v_add_f32_dpp v144, v144, v144 row_ror:12 row_mask:0xf bank_mask:0x5
    v_add_f32_dpp v145, v145, v145 row_ror:12 row_mask:0xf bank_mask:0x5
    v_add_f32_dpp v146, v146, v146 row_ror:12 row_mask:0xf bank_mask:0x5
    v_add_f32_dpp v147, v147, v147 row_ror:12 row_mask:0xf bank_mask:0x5
    v_add_f32_dpp v144, v148, v148 row_ror:4 row_mask:0xf bank_mask:0xa
    v_add_f32_dpp v145, v149, v149 row_ror:4 row_mask:0xf bank_mask:0xa
    v_add_f32_dpp v146, v150, v150 row_ror:4 row_mask:0xf bank_mask:0xa
    v_add_f32_dpp v147, v151, v151 row_ror:4 row_mask:0xf bank_mask:0xa
    ds_write_b128 v129, v[144:147]
    s_waitcnt lgkmcnt(0)
    s_barrier
    s_cmp_lg_u32 s3, 4
    s_cbranch_scc1 L_end
    ds_read_b128 v[16:19], v130 offset:0
    ds_read_b128 v[20:23], v130 offset:1024
    ds_read_b128 v[24:27], v130 offset:2048
    ds_read_b128 v[28:31], v130 offset:3072
    s_waitcnt lgkmcnt(2)
    v_add_f32 v16, v16, v20
    v_add_f32 v17, v17, v21
    v_add_f32 v18, v18, v22
    v_add_f32 v19, v19, v23
    s_waitcnt lgkmcnt(0)
    v_add_f32 v24, v24, v28
    v_add_f32 v25, v25, v29
    v_add_f32 v26, v26, v30
    v_add_f32 v27, v27, v31
    v_add_f32 v16, v16, v24
    v_add_f32 v17, v17, v25
    v_add_f32 v18, v18, v26
    v_add_f32 v19, v19, v27
    v_cvt_pk_bf16_f32 v16, v16, v17
    v_cvt_pk_bf16_f32 v17, v18, v19
    buffer_store_dwordx2 v[16:17], v131, s[12:15], s99 offen sc1
    s_cmp_lg_u32 s63, 0
    s_cbranch_scc1 L_efend
    s_mov_b64 exec, 1
    s_cmp_eq_u32 s53, 0
    s_cbranch_scc1 L_dfar
    buffer_store_dword v132, off, s[12:15], s98
    s_branch L_efend
L_dfar:
    buffer_store_dword v132, off, s[12:15], s98 sc1
    s_branch L_efend
L_dnan:
    v_max3_u32 v10, v16, v17, v18
    v_max3_u32 v10, v10, v19, v20
    v_max3_u32 v10, v10, v21, v22
    v_max3_u32 v10, v10, v23, v24
    v_max3_u32 v10, v10, v25, v26
    v_max3_u32 v10, v10, v27, v28
    v_max3_u32 v10, v10, v29, v30
    v_max_u32 v10, v10, v31
    v_cmp_eq_u32 vcc, -1, v10
    s_nop 3
    s_cbranch_vccz L_dok
    s_sub_u32 s60, s60, 1
    s_cbranch_scc0 L_dre
    s_branch L_dok
L_E2:
    ds_read_b64_tr_b16 v[64:65], v227 offset:0
    ds_read_b64_tr_b16 v[66:67], v227 offset:256
    ds_read_b64_tr_b16 v[68:69], v227 offset:32
    ds_read_b64_tr_b16 v[70:71], v227 offset:288
    ds_read_b64_tr_b16 v[72:73], v227 offset:8192
    ds_read_b64_tr_b16 v[74:75], v227 offset:8448
    ds_read_b64_tr_b16 v[76:77], v227 offset:8224
    ds_read_b64_tr_b16 v[78:79], v227 offset:8480
    v_xor_b32 v9, 0, v226
    ds_read_b64_tr_b16 v[192:193], v9 offset:0
    ds_read_b64_tr_b16 v[194:195], v9 offset:1024
    ds_read_b64_tr_b16 v[196:197], v9 offset:8
    ds_read_b64_tr_b16 v[198:199], v9 offset:1032
    s_waitcnt lgkmcnt(2)
    ds_read_b64_tr_b16 v[80:81], v227 offset:2048
    ds_read_b64_tr_b16 v[82:83], v227 offset:2304
    ds_read_b64_tr_b16 v[84:85], v227 offset:2080
    ds_read_b64_tr_b16 v[86:87], v227 offset:2336
    ds_read_b64_tr_b16 v[88:89], v227 offset:10240
    ds_read_b64_tr_b16 v[90:91], v227 offset:10496
    ds_read_b64_tr_b16 v[92:93], v227 offset:10272
    ds_read_b64_tr_b16 v[94:95], v227 offset:10528
    v_xor_b32 v9, 64, v226
    ds_read_b64_tr_b16 v[200:201], v9 offset:0
    ds_read_b64_tr_b16 v[202:203], v9 offset:1024
    ds_read_b64_tr_b16 v[204:205], v9 offset:8
    ds_read_b64_tr_b16 v[206:207], v9 offset:1032
    s_waitcnt lgkmcnt(2)
    ds_read_b64_tr_b16 v[96:97], v227 offset:4096
    ds_read_b64_tr_b16 v[98:99], v227 offset:4352
    ds_read_b64_tr_b16 v[100:101], v227 offset:4128
    ds_read_b64_tr_b16 v[102:103], v227 offset:4384
    ds_read_b64_tr_b16 v[104:105], v227 offset:12288
    ds_read_b64_tr_b16 v[106:107], v227 offset:12544
    ds_read_b64_tr_b16 v[108:109], v227 offset:12320
    ds_read_b64_tr_b16 v[110:111], v227 offset:12576
    v_xor_b32 v9, 128, v226
    ds_read_b64_tr_b16 v[208:209], v9 offset:0
    ds_read_b64_tr_b16 v[210:211], v9 offset:1024
    ds_read_b64_tr_b16 v[212:213], v9 offset:8
    ds_read_b64_tr_b16 v[214:215], v9 offset:1032
    s_waitcnt lgkmcnt(2)
    ds_read_b64_tr_b16 v[112:113], v227 offset:6144
    ds_read_b64_tr_b16 v[114:115], v227 offset:6400
    ds_read_b64_tr_b16 v[116:117], v227 offset:6176
    ds_read_b64_tr_b16 v[118:119], v227 offset:6432
    ds_read_b64_tr_b16 v[120:121], v227 offset:14336
    ds_read_b64_tr_b16 v[122:123], v227 offset:14592
    ds_read_b64_tr_b16 v[124:125], v227 offset:14368
    ds_read_b64_tr_b16 v[126:127], v227 offset:14624
    v_xor_b32 v9, 192, v226
    ds_read_b64_tr_b16 v[216:217], v9 offset:0
    ds_read_b64_tr_b16 v[218:219], v9 offset:1024
    ds_read_b64_tr_b16 v[220:221], v9 offset:8
    ds_read_b64_tr_b16 v[222:223], v9 offset:1032
    s_waitcnt lgkmcnt(0)
    v_mfma_f32_16x16x32_bf16 v[164:167], v[64:67], v[148:151], 0
    v_mfma_f32_16x16x32_bf16 v[168:171], v[68:71], v[148:151], 0
    v_mfma_f32_16x16x32_bf16 v[172:175], v[72:75], v[148:151], 0
    v_mfma_f32_16x16x32_bf16 v[176:179], v[76:79], v[148:151], 0
    v_mfma_f32_16x16x32_bf16 v[164:167], v[80:83], v[148:151], v[164:167]
    v_mfma_f32_16x16x32_bf16 v[168:171], v[84:87], v[148:151], v[168:171]
    v_mfma_f32_16x16x32_bf16 v[172:175], v[88:91], v[148:151], v[172:175]
    v_mfma_f32_16x16x32_bf16 v[176:179], v[92:95], v[148:151], v[176:179]
    v_mfma_f32_16x16x32_bf16 v[164:167], v[96:99], v[148:151], v[164:167]
    v_mfma_f32_16x16x32_bf16 v[168:171], v[100:103], v[148:151], v[168:171]
    v_mfma_f32_16x16x32_bf16 v[172:175], v[104:107], v[148:151], v[172:175]
    v_mfma_f32_16x16x32_bf16 v[176:179], v[108:111], v[148:151], v[176:179]
    v_mfma_f32_16x16x32_bf16 v[164:167], v[112:115], v[148:151], v[164:167]
    v_mfma_f32_16x16x32_bf16 v[168:171], v[116:119], v[148:151], v[168:171]
    v_mfma_f32_16x16x32_bf16 v[172:175], v[120:123], v[148:151], v[172:175]
    v_mfma_f32_16x16x32_bf16 v[176:179], v[124:127], v[148:151], v[176:179]
    v_lshlrev_b32 v132, 16, v128
    v_and_b32 v133, s62, v128
    v_lshlrev_b32 v134, 16, v129
    v_and_b32 v135, s62, v129
    v_lshlrev_b32 v136, 16, v130
    v_and_b32 v137, s62, v130
    v_lshlrev_b32 v138, 16, v131
    v_and_b32 v139, s62, v131
    s_mov_b32 exec_lo, 0xf000f
    s_mov_b32 exec_hi, 0xf000f
    ds_write_b128 v180, v[164:167] offset:0
    ds_write_b128 v180, v[168:171] offset:64
    ds_write_b128 v180, v[172:175] offset:128
    ds_write_b128 v180, v[176:179] offset:192
    s_mov_b64 exec, -1
    s_lshl_b32 s98, s63, 7
    s_mul_i32 s93, s94, 49152
    s_add_u32 s98, s98, s93
    s_add_u32 s98, s98, 425984
    s_mul_i32 s99, s63, 6144
    s_add_u32 s99, s99, 425984
    s_add_u32 s97, s99, 4096
    s_lshr_b32 s96, s63, 1
    s_lshl_b32 s96, s96, 6
    s_lshl_b32 s90, s94, 10
    s_add_u32 s90, s90, 393216
    s_waitcnt lgkmcnt(0)
    s_mov_b32 s91, 0xbdd2d3e8
    v_mov_b32 v228, 0xc0135761
    s_barrier
    ds_read_b32 v16, v182 offset:0
    ds_read_b32 v17, v182 offset:128
    ds_read_b32 v18, v182 offset:16384
    ds_read_b32 v19, v182 offset:16512
    ds_read_b32 v20, v182 offset:32768
    ds_read_b32 v21, v182 offset:32896
    ds_read_b32 v22, v182 offset:49152
    ds_read_b32 v23, v182 offset:49280
    s_waitcnt lgkmcnt(0)
    v_add_f32 v186, v16, v18
    v_add_f32 v187, v17, v19
    v_add_f32 v186, v186, v20
    v_add_f32 v187, v187, v21
    v_add_f32 v186, v186, v22
    v_add_f32 v187, v187, v23
    s_barrier
    s_lshl_b32 s92, s7, 7
    s_add_u32 s92, s92, 180224
    s_mov_b64 exec, 1
    s_mov_b32 s60, 200000
poll_4:
    buffer_load_dword v9, off, s[12:15], s92 sc1
    s_waitcnt vmcnt(0)
    v_cmp_ne_u32 vcc, s56, v9
    s_nop 3
    s_cbranch_vccz pdone_5
    s_sub_u32 s60, s60, 1
    s_cbranch_scc0 poll_4
pdone_5:
    s_mov_b64 exec, -1
    s_mov_b32 s60, 200000
L_ere:
    s_mov_b32 s92, s90
    buffer_load_dwordx4 v[16:19], v185, s[12:15], s92 offen sc1
    s_add_u32 s92, s92, 4096
    buffer_load_dwordx4 v[20:23], v185, s[12:15], s92 offen sc1
    s_add_u32 s92, s92, 4096
    buffer_load_dwordx4 v[24:27], v185, s[12:15], s92 offen sc1
    s_add_u32 s92, s92, 4096
    buffer_load_dwordx4 v[28:31], v185, s[12:15], s92 offen sc1
    s_add_u32 s92, s92, 4096
    buffer_load_dwordx4 v[32:35], v185, s[12:15], s92 offen sc1
    s_add_u32 s92, s92, 4096
    buffer_load_dwordx4 v[36:39], v185, s[12:15], s92 offen sc1
    s_add_u32 s92, s92, 4096
    buffer_load_dwordx4 v[40:43], v185, s[12:15], s92 offen sc1
    s_add_u32 s92, s92, 4096
    buffer_load_dwordx4 v[44:47], v185, s[12:15], s92 offen sc1
    s_waitcnt vmcnt(7)
    v_dot2_f32_bf16 v140, v16, s58, v132
    v_dot2_f32_bf16 v141, v16, s59, v133
    v_dot2_f32_bf16 v142, v17, s58, v134
    v_dot2_f32_bf16 v143, v17, s59, v135
    v_dot2_f32_bf16 v144, v18, s58, v136
    v_dot2_f32_bf16 v145, v18, s59, v137
    v_dot2_f32_bf16 v146, v19, s58, v138
    v_dot2_f32_bf16 v147, v19, s59, v139
    s_waitcnt vmcnt(6)
    v_dot2_f32_bf16 v140, v20, s58, v140
    v_dot2_f32_bf16 v141, v20, s59, v141
    v_dot2_f32_bf16 v142, v21, s58, v142
    v_dot2_f32_bf16 v143, v21, s59, v143
    v_dot2_f32_bf16 v144, v22, s58, v144
    v_dot2_f32_bf16 v145, v22, s59, v145
    v_dot2_f32_bf16 v146, v23, s58, v146
    v_dot2_f32_bf16 v147, v23, s59, v147
    s_waitcnt vmcnt(5)
    v_dot2_f32_bf16 v140, v24, s58, v140
    v_dot2_f32_bf16 v141, v24, s59, v141
    v_dot2_f32_bf16 v142, v25, s58, v142
    v_dot2_f32_bf16 v143, v25, s59, v143
    v_dot2_f32_bf16 v144, v26, s58, v144
    v_dot2_f32_bf16 v145, v26, s59, v145
    v_dot2_f32_bf16 v146, v27, s58, v146
    v_dot2_f32_bf16 v147, v27, s59, v147
    s_waitcnt vmcnt(4)
    v_dot2_f32_bf16 v140, v28, s58, v140
    v_dot2_f32_bf16 v141, v28, s59, v141
    v_dot2_f32_bf16 v142, v29, s58, v142
    v_dot2_f32_bf16 v143, v29, s59, v143
    v_dot2_f32_bf16 v144, v30, s58, v144
    v_dot2_f32_bf16 v145, v30, s59, v145
    v_dot2_f32_bf16 v146, v31, s58, v146
    v_dot2_f32_bf16 v147, v31, s59, v147
    s_waitcnt vmcnt(3)
    v_dot2_f32_bf16 v140, v32, s58, v140
    v_dot2_f32_bf16 v141, v32, s59, v141
    v_dot2_f32_bf16 v142, v33, s58, v142
    v_dot2_f32_bf16 v143, v33, s59, v143
    v_dot2_f32_bf16 v144, v34, s58, v144
    v_dot2_f32_bf16 v145, v34, s59, v145
    v_dot2_f32_bf16 v146, v35, s58, v146
    v_dot2_f32_bf16 v147, v35, s59, v147
    s_waitcnt vmcnt(2)
    v_dot2_f32_bf16 v140, v36, s58, v140
    v_dot2_f32_bf16 v141, v36, s59, v141
    v_dot2_f32_bf16 v142, v37, s58, v142
    v_dot2_f32_bf16 v143, v37, s59, v143
    v_dot2_f32_bf16 v144, v38, s58, v144
    v_dot2_f32_bf16 v145, v38, s59, v145
    v_dot2_f32_bf16 v146, v39, s58, v146
    v_dot2_f32_bf16 v147, v39, s59, v147
    s_waitcnt vmcnt(1)
    v_dot2_f32_bf16 v140, v40, s58, v140
    v_dot2_f32_bf16 v141, v40, s59, v141
    v_dot2_f32_bf16 v142, v41, s58, v142
    v_dot2_f32_bf16 v143, v41, s59, v143
    v_dot2_f32_bf16 v144, v42, s58, v144
    v_dot2_f32_bf16 v145, v42, s59, v145
    v_dot2_f32_bf16 v146, v43, s58, v146
    v_dot2_f32_bf16 v147, v43, s59, v147
    s_waitcnt vmcnt(0)
    v_dot2_f32_bf16 v140, v44, s58, v140
    v_dot2_f32_bf16 v141, v44, s59, v141
    v_dot2_f32_bf16 v142, v45, s58, v142
    v_dot2_f32_bf16 v143, v45, s59, v143
    v_dot2_f32_bf16 v144, v46, s58, v144
    v_dot2_f32_bf16 v145, v46, s59, v145
    v_dot2_f32_bf16 v146, v47, s58, v146
    v_dot2_f32_bf16 v147, v47, s59, v147
    v_cvt_pk_bf16_f32 v148, v140, v141
    v_cvt_pk_bf16_f32 v149, v142, v143
    v_cvt_pk_bf16_f32 v150, v144, v145
    v_cvt_pk_bf16_f32 v151, v146, v147
    v_mov_b32_dpp v152, v148 row_shl:4 row_mask:0xf bank_mask:0xf bound_ctrl:0
    v_mov_b32_dpp v153, v149 row_shl:4 row_mask:0xf bank_mask:0xf bound_ctrl:0
    v_mov_b32_dpp v154, v150 row_shl:4 row_mask:0xf bank_mask:0xf bound_ctrl:0
    v_mov_b32_dpp v155, v151 row_shl:4 row_mask:0xf bank_mask:0xf bound_ctrl:0
    v_mfma_f32_16x16x32_bf16 v[164:167], v[64:67], v[148:151], 0
    v_mfma_f32_16x16x32_bf16 v[168:171], v[68:71], v[148:151], 0
    v_mfma_f32_16x16x32_bf16 v[172:175], v[72:75], v[148:151], 0
    v_mfma_f32_16x16x32_bf16 v[176:179], v[76:79], v[148:151], 0
    ds_write_b128 v190, v[148:151]
    v_dot2_f32_bf16 v9, v148, s57, 0
    v_dot2_f32_bf16 v11, v148, v148, 0
    v_dot2_f32_bf16 v9, v149, s57, v9
    v_dot2_f32_bf16 v11, v149, v149, v11
    v_dot2_f32_bf16 v9, v150, s57, v9
    v_dot2_f32_bf16 v11, v150, v150, v11
    v_dot2_f32_bf16 v9, v151, s57, v9
    v_dot2_f32_bf16 v11, v151, v151, v11
    v_mov_b32_dpp v156, v148 row_shl:8 row_mask:0xf bank_mask:0xf bound_ctrl:0
    v_mov_b32_dpp v157, v149 row_shl:8 row_mask:0xf bank_mask:0xf bound_ctrl:0
    v_mov_b32_dpp v158, v150 row_shl:8 row_mask:0xf bank_mask:0xf bound_ctrl:0
    v_mov_b32_dpp v159, v151 row_shl:8 row_mask:0xf bank_mask:0xf bound_ctrl:0
    v_mfma_f32_16x16x32_bf16 v[164:167], v[80:83], v[152:155], v[164:167]
    v_mfma_f32_16x16x32_bf16 v[168:171], v[84:87], v[152:155], v[168:171]
    v_mfma_f32_16x16x32_bf16 v[172:175], v[88:91], v[152:155], v[172:175]
    v_mfma_f32_16x16x32_bf16 v[176:179], v[92:95], v[152:155], v[176:179]
    v_cmp_u_f32 vcc, v9, v9
    v_add_f32_dpp v9, v9, v9 row_ror:4 row_mask:0xf bank_mask:0xf
    v_add_f32_dpp v11, v11, v11 row_ror:4 row_mask:0xf bank_mask:0xf
    s_nop 0
    v_add_f32_dpp v9, v9, v9 row_ror:8 row_mask:0xf bank_mask:0xf
    v_add_f32_dpp v11, v11, v11 row_ror:8 row_mask:0xf bank_mask:0xf
    s_cbranch_vccnz L_enan
L_eok:
    v_mov_b32_dpp v160, v148 row_shl:12 row_mask:0xf bank_mask:0xf bound_ctrl:0
    v_mov_b32_dpp v161, v149 row_shl:12 row_mask:0xf bank_mask:0xf bound_ctrl:0
    v_mov_b32_dpp v162, v150 row_shl:12 row_mask:0xf bank_mask:0xf bound_ctrl:0
    v_mov_b32_dpp v163, v151 row_shl:12 row_mask:0xf bank_mask:0xf bound_ctrl:0
    v_mfma_f32_16x16x32_bf16 v[164:167], v[96:99], v[156:159], v[164:167]
    v_mfma_f32_16x16x32_bf16 v[168:171], v[100:103], v[156:159], v[168:171]
    v_mfma_f32_16x16x32_bf16 v[172:175], v[104:107], v[156:159], v[172:175]
    v_mfma_f32_16x16x32_bf16 v[176:179], v[108:111], v[156:159], v[176:179]
    v_permlane16_swap_b32 v9, v11
    v_add_f32 v9, v9, v11
    v_mov_b32 v11, v9
    s_nop 1
    v_permlane32_swap_b32 v9, v11
    v_add_f32 v9, v9, v11
    v_mfma_f32_16x16x32_bf16 v[164:167], v[112:115], v[160:163], v[164:167]
    v_mfma_f32_16x16x32_bf16 v[168:171], v[116:119], v[160:163], v[168:171]
    v_mfma_f32_16x16x32_bf16 v[172:175], v[120:123], v[160:163], v[172:175]
    v_mfma_f32_16x16x32_bf16 v[176:179], v[124:127], v[160:163], v[176:179]
    s_mov_b32 exec_lo, 0xf000f
    s_mov_b32 exec_hi, 0x0
    ds_write_b32 v181, v9 offset:1024
    s_mov_b32 exec_lo, 0xf000f
    s_mov_b32 exec_hi, 0xf000f
    ds_write_b128 v180, v[164:167] offset:0
    ds_write_b128 v180, v[168:171] offset:64
    ds_write_b128 v180, v[172:175] offset:128
    ds_write_b128 v180, v[176:179] offset:192
    s_mov_b64 exec, -1
    s_waitcnt lgkmcnt(0)
    s_barrier
    s_cmp_ge_u32 s3, 6
    s_cbranch_scc1 L_eact
    ds_read_b64 v[24:25], v183 offset:1024
    ds_read_b64 v[26:27], v183 offset:17408
    ds_read_b64 v[28:29], v183 offset:33792
    ds_read_b64 v[30:31], v183 offset:50176
    ds_read_b32 v16, v182 offset:0
    ds_read_b32 v17, v182 offset:128
    ds_read_b32 v18, v182 offset:16384
    ds_read_b32 v19, v182 offset:16512
    ds_read_b32 v20, v182 offset:32768
    ds_read_b32 v21, v182 offset:32896
    ds_read_b32 v22, v182 offset:49152
    ds_read_b32 v23, v182 offset:49280
    s_waitcnt lgkmcnt(8)
    v_add_f32 v24, v24, v26
    v_add_f32 v25, v25, v27
    v_add_f32 v24, v24, v28
    v_add_f32 v25, v25, v29
    v_add_f32 v24, v24, v30
    v_add_f32 v25, v25, v31
    v_mul_f32 v24, 0x3b000000, v24
    v_mul_f32 v25, 0x3b000000, v25
    v_fma_f32 v25, -v24, v24, v25
    v_max_f32 v25, 0, v25
    v_add_f32 v25, 0x3727c5ac, v25
    v_rsq_f32 v25, v25
    s_waitcnt lgkmcnt(0)
    v_add_f32 v16, v16, v18
    v_add_f32 v17, v17, v19
    v_add_f32 v16, v16, v20
    v_add_f32 v17, v17, v21
    v_add_f32 v16, v16, v22
    v_add_f32 v17, v17, v23
    v_fma_f32 v16, -v24, v186, v16
    v_fma_f32 v17, -v24, v187, v17
    v_mul_f32 v16, v16, v25
    v_mul_f32 v17, v17, v25
    v_mul_f32 v18, v16, v16
    v_fma_f32 v19, v18, s91, v228
    v_mul_f32 v19, v19, v16
    v_exp_f32 v19, v19
    v_mul_f32 v16, v16, v17
    v_add_f32 v19, 1.0, v19
    v_rcp_f32 v19, v19
    s_nop 0
    v_mul_f32 v16, v16, v19
    s_nop 1
    v_mov_b32_dpp v17, v16 quad_perm:[1,1,3,3] row_mask:0xf bank_mask:0xf
    v_cvt_pk_bf16_f32 v16, v16, v17
    s_mov_b32 exec_lo, 0x55555555
    s_mov_b32 exec_hi, 0x55555555
    ds_write_b32 v184, v16
    s_mov_b64 exec, -1
    s_waitcnt lgkmcnt(0)
L_eact:
    s_barrier
    ds_read_b128 v[16:19], v188
    ds_read_b128 v[20:23], v224
    s_waitcnt lgkmcnt(1)
    v_mfma_f32_16x16x32_bf16 v[64:67], v[192:195], v[16:19], 0
    v_mfma_f32_16x16x32_bf16 v[68:71], v[196:199], v[16:19], 0
    v_mfma_f32_16x16x32_bf16 v[72:75], v[200:203], v[16:19], 0
    v_mfma_f32_16x16x32_bf16 v[76:79], v[204:207], v[16:19], 0
    v_mfma_f32_16x16x32_bf16 v[80:83], v[208:211], v[16:19], 0
    v_mfma_f32_16x16x32_bf16 v[84:87], v[212:215], v[16:19], 0
    v_mfma_f32_16x16x32_bf16 v[88:91], v[216:219], v[16:19], 0
    v_mfma_f32_16x16x32_bf16 v[92:95], v[220:223], v[16:19], 0
    s_mov_b32 exec_lo, 0xf000f
    s_mov_b32 exec_hi, 0xf000f
    v_cvt_pk_bf16_f32 v96, v64, v65
    v_cvt_pk_bf16_f32 v97, v66, v67
    v_cvt_pk_bf16_f32 v98, v68, v69
    v_cvt_pk_bf16_f32 v99, v70, v71
    buffer_store_dwordx4 v[96:99], v189, s[12:15], s98 offen sc1
    s_add_u32 s98, s98, 12288
    v_cvt_pk_bf16_f32 v100, v72, v73
    v_cvt_pk_bf16_f32 v101, v74, v75
    v_cvt_pk_bf16_f32 v102, v76, v77
    v_cvt_pk_bf16_f32 v103, v78, v79
    buffer_store_dwordx4 v[100:103], v189, s[12:15], s98 offen sc1
    s_add_u32 s98, s98, 12288
    v_cvt_pk_bf16_f32 v104, v80, v81
    v_cvt_pk_bf16_f32 v105, v82, v83
    v_cvt_pk_bf16_f32 v106, v84, v85
    v_cvt_pk_bf16_f32 v107, v86, v87
    buffer_store_dwordx4 v[104:107], v189, s[12:15], s98 offen sc1
    s_add_u32 s98, s98, 12288
    v_cvt_pk_bf16_f32 v108, v88, v89
    v_cvt_pk_bf16_f32 v109, v90, v91
    v_cvt_pk_bf16_f32 v110, v92, v93
    v_cvt_pk_bf16_f32 v111, v94, v95
    buffer_store_dwordx4 v[108:111], v189, s[12:15], s98 offen sc1
    s_mov_b64 exec, -1
    s_cmp_lg_u32 s3, 4
    s_cbranch_scc1 L_end
    s_cmp_ge_u32 s63, 32
    s_cbranch_scc1 L_efend
    v_mov_b32 v56, 0
    v_mov_b32 v57, 0
    v_mov_b32 v58, 0
    v_mov_b32 v59, 0
    v_mov_b32 v60, 0
    v_mov_b32 v61, 0
    v_mov_b32 v62, 0
    v_mov_b32 v63, 0
    s_waitcnt lgkmcnt(0)
    s_mov_b32 exec_lo, 0xff
    s_mov_b32 exec_hi, 0x0
    v_dot2_f32_bf16 v56, v20, s58, 0
    v_dot2_f32_bf16 v57, v20, s59, 0
    v_dot2_f32_bf16 v58, v21, s58, 0
    v_dot2_f32_bf16 v59, v21, s59, 0
    v_dot2_f32_bf16 v60, v22, s58, 0
    v_dot2_f32_bf16 v61, v22, s59, 0
    v_dot2_f32_bf16 v62, v23, s58, 0
    v_dot2_f32_bf16 v63, v23, s59, 0
    s_mov_b64 exec, -1
    s_mov_b32 s60, 200000
    s_waitcnt vmcnt(0)
L_gre:
    buffer_load_dwordx4 v[24:27], v2, s[12:15], s99 offen offset:0 sc1
    buffer_load_dwordx4 v[28:31], v2, s[12:15], s99 offen offset:1024 sc1
    buffer_load_dwordx4 v[32:35], v2, s[12:15], s99 offen offset:2048 sc1
    buffer_load_dwordx4 v[36:39], v2, s[12:15], s99 offen offset:3072 sc1
    buffer_load_dwordx4 v[40:43], v2, s[12:15], s97 offen offset:0 sc1
    buffer_load_dwordx4 v[44:47], v191, s[12:15], s97 offen offset:1024 sc1
    s_waitcnt vmcnt(5)
    v_dot2_f32_bf16 v48, v24, s58, v56
    v_dot2_f32_bf16 v49, v24, s59, v57
    v_dot2_f32_bf16 v50, v25, s58, v58
    v_dot2_f32_bf16 v51, v25, s59, v59
    v_dot2_f32_bf16 v52, v26, s58, v60
    v_dot2_f32_bf16 v53, v26, s59, v61
    v_dot2_f32_bf16 v54, v27, s58, v62
    v_dot2_f32_bf16 v55, v27, s59, v63
    s_waitcnt vmcnt(4)
    v_dot2_f32_bf16 v48, v28, s58, v48
    v_dot2_f32_bf16 v49, v28, s59, v49
    v_dot2_f32_bf16 v50, v29, s58, v50
    v_dot2_f32_bf16 v51, v29, s59, v51
    v_dot2_f32_bf16 v52, v30, s58, v52
    v_dot2_f32_bf16 v53, v30, s59, v53
    v_dot2_f32_bf16 v54, v31, s58, v54
    v_dot2_f32_bf16 v55, v31, s59, v55
    s_waitcnt vmcnt(3)
    v_dot2_f32_bf16 v48, v32, s58, v48
    v_dot2_f32_bf16 v49, v32, s59, v49
    v_dot2_f32_bf16 v50, v33, s58, v50
    v_dot2_f32_bf16 v51, v33, s59, v51
    v_dot2_f32_bf16 v52, v34, s58, v52
    v_dot2_f32_bf16 v53, v34, s59, v53
    v_dot2_f32_bf16 v54, v35, s58, v54
    v_dot2_f32_bf16 v55, v35, s59, v55
    s_waitcnt vmcnt(2)
    v_dot2_f32_bf16 v48, v36, s58, v48
    v_dot2_f32_bf16 v49, v36, s59, v49
    v_dot2_f32_bf16 v50, v37, s58, v50
    v_dot2_f32_bf16 v51, v37, s59, v51
    v_dot2_f32_bf16 v52, v38, s58, v52
    v_dot2_f32_bf16 v53, v38, s59, v53
    v_dot2_f32_bf16 v54, v39, s58, v54
    v_dot2_f32_bf16 v55, v39, s59, v55
    s_waitcnt vmcnt(1)
    v_dot2_f32_bf16 v48, v40, s58, v48
    v_dot2_f32_bf16 v49, v40, s59, v49
    v_dot2_f32_bf16 v50, v41, s58, v50
    v_dot2_f32_bf16 v51, v41, s59, v51
    v_dot2_f32_bf16 v52, v42, s58, v52
    v_dot2_f32_bf16 v53, v42, s59, v53
    v_dot2_f32_bf16 v54, v43, s58, v54
    v_dot2_f32_bf16 v55, v43, s59, v55
    s_waitcnt vmcnt(0)
    v_dot2_f32_bf16 v48, v44, s58, v48
    v_dot2_f32_bf16 v49, v44, s59, v49
    v_dot2_f32_bf16 v50, v45, s58, v50
    v_dot2_f32_bf16 v51, v45, s59, v51
    v_dot2_f32_bf16 v52, v46, s58, v52
    v_dot2_f32_bf16 v53, v46, s59, v53
    v_dot2_f32_bf16 v54, v47, s58, v54
    v_dot2_f32_bf16 v55, v47, s59, v55
    v_permlane16_swap_b32 v48, v49
    v_permlane16_swap_b32 v50, v51
    v_permlane16_swap_b32 v52, v53
    v_permlane16_swap_b32 v54, v55
    v_add_f32 v48, v48, v49
    v_add_f32 v50, v50, v51
    v_add_f32 v52, v52, v53
    v_add_f32 v54, v54, v55
    v_permlane32_swap_b32 v48, v50
    s_nop 0
    v_permlane32_swap_b32 v52, v54
    v_add_f32 v48, v48, v50
    v_add_f32 v52, v52, v54
    v_cmp_u_f32 vcc, v48, v52
    v_add_f32_dpp v48, v48, v48 row_ror:8 row_mask:0xf bank_mask:0xf
    v_add_f32_dpp v52, v52, v52 row_ror:8 row_mask:0xf bank_mask:0xf
    v_cvt_pk_bf16_f32 v48, v48, v52
    s_cbranch_vccnz L_gnan
L_gok:
    s_mov_b32 exec_lo, 0xff00ff
    s_mov_b32 exec_hi, 0xff00ff
    buffer_store_short v48, v225, s[48:51], s96 offen
    buffer_store_short_d16_hi v48, v225, s[48:51], s96 offen offset:8
    s_cmp_lg_u32 s63, 0
    s_cbranch_scc1 L_efend
    s_mov_b64 exec, 1
    v_mov_b32 v12, s56
    s_mov_b32 s90, 192512
    buffer_store_dword v12, off, s[12:15], s90
L_efend:
    s_endpgm
L_enan:
    v_max3_u32 v10, v16, v17, v18
    v_max3_u32 v10, v10, v19, v20
    v_max3_u32 v10, v10, v21, v22
    v_max3_u32 v10, v10, v23, v24
    v_max3_u32 v10, v10, v25, v26
    v_max3_u32 v10, v10, v27, v28
    v_max3_u32 v10, v10, v29, v30
    v_max3_u32 v10, v10, v31, v32
    v_max3_u32 v10, v10, v33, v34
    v_max3_u32 v10, v10, v35, v36
    v_max3_u32 v10, v10, v37, v38
    v_max3_u32 v10, v10, v39, v40
    v_max3_u32 v10, v10, v41, v42
    v_max3_u32 v10, v10, v43, v44
    v_max3_u32 v10, v10, v45, v46
    v_max_u32 v10, v10, v47
    v_cmp_eq_u32 vcc, -1, v10
    s_nop 3
    s_cbranch_vccz L_eok
    s_sub_u32 s60, s60, 1
    s_cbranch_scc0 L_ere
    s_branch L_eok
L_gnan:
    v_max3_u32 v10, v24, v25, v26
    v_max3_u32 v10, v10, v27, v28
    v_max3_u32 v10, v10, v29, v30
    v_max3_u32 v10, v10, v31, v32
    v_max3_u32 v10, v10, v33, v34
    v_max3_u32 v10, v10, v35, v36
    v_max3_u32 v10, v10, v37, v38
    v_max3_u32 v10, v10, v39, v40
    v_max3_u32 v10, v10, v41, v42
    v_max3_u32 v10, v10, v43, v44
    v_max3_u32 v10, v10, v45, v46
    v_max_u32 v10, v10, v47
    v_cmp_eq_u32 vcc, -1, v10
    s_nop 3
    s_cbranch_vccz L_gok
    s_sub_u32 s60, s60, 1
    s_cbranch_scc0 L_gre
    s_branch L_gok
L_att:
    s_mov_b32 s18, 33554432
    s_mov_b32 s19, 0x00020000
    s_bfe_u32 s4, s2, 0x20001
    s_bfe_u32 s5, s2, 0x40003
    s_lshl_b32 s5, s5, 1
    s_and_b32 s6, s2, 1
    s_add_u32 s5, s5, s6
    s_lshl_b32 s90, s4, 23
    s_lshl_b32 s91, s5, 18
    s_add_u32 s90, s90, s91
    s_and_b32 s7, s3, 3
    s_lshl_b32 s91, s7, 14
    s_add_u32 s90, s90, s91
    s_and_b32 s91, s7, 1
    s_mul_i32 s91, s91, 262144
    s_xor_b32 s90, s90, s91
    s_lshl_b32 s91, s7, 15
    s_lshl_b32 s92, s7, 2
    s_add_u32 s92, s92, 162816
    v_mov_b32 v7, s92
    v_lshlrev_b32 v10, 2, v4
    v_add_u32 v10, 162816, v10
    s_cmp_lt_u32 s3, 4
    s_cbranch_scc1 L_comp
    s_mov_b32 s3, s7
    v_xor_b32 v12, 0, v2
    v_xor_b32 v13, 32, v2
    v_xor_b32 v14, 64, v2
    v_xor_b32 v15, 96, v2
    v_xor_b32 v16, 128, v2
    v_xor_b32 v17, 160, v2
    v_xor_b32 v18, 192, v2
    v_xor_b32 v19, 224, v2
    s_mov_b32 m0, s91
    s_mov_b32 s93, 0
    s_waitcnt lgkmcnt(0)
    s_mov_b64 s[16:17], s[66:67]
    buffer_load_dwordx4 v12, s[16:19], s90 offen offset:0 nt lds
    s_load_dword s56, s[12:13], 192512
    s_barrier
    v_bfe_u32 v40, v1, 2, 2
    v_lshrrev_b32 v42, 5, v1
    v_lshlrev_b32 v41, 2, v40
    v_lshl_add_u32 v41, v42, 1, v41
    v_and_b32 v43, 1, v3
    v_lshlrev_b32 v44, 1, v43
    v_bfe_u32 v45, v1, 1, 1
    v_add_u32 v44, v44, v45
    v_xor_b32 v44, v44, v41
    v_lshlrev_b32 v41, 10, v41
    v_lshl_add_u32 v41, v44, 4, v41
    v_and_b32 v45, 1, v1
    v_lshl_add_u32 v41, v45, 3, v41
    s_lshl_b32 s95, s3, 8
    v_add_u32 v41, s95, v41
    v_xor_b32 v20, 0, v41
    v_xor_b32 v21, 64, v41
    v_xor_b32 v22, 128, v41
    v_xor_b32 v23, 192, v41
    v_xor_b32 v24, 65536, v41
    v_xor_b32 v25, 65600, v41
    v_xor_b32 v26, 65664, v41
    v_xor_b32 v27, 65728, v41
    v_add_u32 v28, 131072, v2
    v_lshlrev_b32 v33, 4, v42
    v_add_u32 v33, 147456, v33
    v_lshl_add_u32 v42, v42, 2, v43
    v_lshlrev_b32 v29, 17, v42
    v_lshl_add_u32 v29, v11, 3, v29
    v_lshl_add_u32 v42, v45, 4, v42
    v_bfe_u32 v44, v1, 2, 1
    v_lshl_add_u32 v42, v44, 3, v42
    v_bfe_u32 v44, v1, 3, 1
    v_lshl_add_u32 v42, v44, 1, v42
    v_lshlrev_b32 v31, 2, v42
    v_add_u32 v31, 147968, v31
    v_lshlrev_b32 v30, 4, v42
    v_add_u32 v32, 163328, v30
    s_lshl_b32 s96, s3, 2
    s_add_u32 s96, s96, s4
    s_lshl_b32 s96, s96, 13
    s_lshl_b32 s95, s5, 8
    s_add_u32 s96, s96, s95
    s_add_u32 s96, s96, 1048576
    s_lshl_b32 s97, s4, 16
    s_lshl_b32 s95, s5, 11
    s_add_u32 s97, s97, s95
    s_lshl_b32 s95, s3, 9
    s_add_u32 s97, s97, s95
    s_add_u32 s97, s97, 5242880
    v_add_u32 v9, s91, v2
    s_waitcnt vmcnt(0)
    buffer_load_dwordx4 v12, s[16:19], s90 offen offset:1024 nt lds
    s_cmp_lg_u32 s93, 0
    s_cbranch_scc1 fast_6
    ds_read_b32 v6, v10 offset:80
    s_waitcnt vmcnt(4)
    s_waitcnt lgkmcnt(0)
    v_cmp_eq_u32 vcc, 0, v6
    s_nop 0
    s_cmp_eq_u64 vcc, 0
    s_cselect_b32 s93, 1, 0
fast_6:
    buffer_load_dwordx4 v13, s[16:19], s90 offen offset:2048 nt lds
    s_cmp_lg_u32 s93, 0
    s_cbranch_scc1 fast_7
    s_waitcnt vmcnt(4)
fast_7:
    buffer_load_dwordx4 v13, s[16:19], s90 offen offset:3072 nt lds
    s_add_u32 s90, s90, 4096
    s_xor_b32 s90, s90, 1048576
    s_add_u32 m0, m0, 4096
    s_cmp_lg_u32 s93, 0
    s_cbranch_scc1 fast_8
    ds_read_b32 v6, v10 offset:80
    s_waitcnt vmcnt(4)
    s_waitcnt lgkmcnt(0)
    v_cmp_eq_u32 vcc, 0, v6
    s_nop 0
    s_cmp_eq_u64 vcc, 0
    s_cselect_b32 s93, 1, 0
fast_8:
    buffer_load_dwordx4 v14, s[16:19], s90 offen offset:0 nt lds
    s_cmp_lg_u32 s93, 0
    s_cbranch_scc1 fast_9
    s_waitcnt vmcnt(4)
fast_9:
    buffer_load_dwordx4 v14, s[16:19], s90 offen offset:1024 nt lds
    s_cmp_lg_u32 s93, 0
    s_cbranch_scc1 fast_10
    ds_read_b32 v6, v10 offset:80
    s_waitcnt vmcnt(4)
    s_waitcnt lgkmcnt(0)
    v_cmp_eq_u32 vcc, 0, v6
    s_nop 0
    s_cmp_eq_u64 vcc, 0
    s_cselect_b32 s93, 1, 0
fast_10:
    buffer_load_dwordx4 v15, s[16:19], s90 offen offset:2048 nt lds
    s_cmp_lg_u32 s93, 0
    s_cbranch_scc1 fast_11
    s_waitcnt vmcnt(4)
fast_11:
    buffer_load_dwordx4 v15, s[16:19], s90 offen offset:3072 nt lds
    s_add_u32 s90, s90, 4096
    s_xor_b32 s90, s90, 524288
    s_add_u32 m0, m0, 4096
    s_cmp_lg_u32 s93, 0
    s_cbranch_scc1 fast_12
    ds_read_b32 v6, v10 offset:80
    s_waitcnt vmcnt(4)
    s_waitcnt lgkmcnt(0)
    v_cmp_eq_u32 vcc, 0, v6
    s_nop 0
    s_cmp_eq_u64 vcc, 0
    s_cselect_b32 s93, 1, 0
fast_12:
    buffer_load_dwordx4 v16, s[16:19], s90 offen offset:0 nt lds
    s_cmp_lg_u32 s93, 0
    s_cbranch_scc1 fast_13
    s_waitcnt vmcnt(4)
fast_13:
    buffer_load_dwordx4 v16, s[16:19], s90 offen offset:1024 nt lds
    s_cmp_lg_u32 s93, 0
    s_cbranch_scc1 fast_14
    ds_read_b32 v6, v10 offset:80
    s_waitcnt vmcnt(4)
    s_waitcnt lgkmcnt(0)
    v_cmp_eq_u32 vcc, 0, v6
    s_nop 0
    s_cmp_eq_u64 vcc, 0
    s_cselect_b32 s93, 1, 0
fast_14:
    buffer_load_dwordx4 v17, s[16:19], s90 offen offset:2048 nt lds
    s_cmp_lg_u32 s93, 0
    s_cbranch_scc1 fast_15
    s_waitcnt vmcnt(4)
fast_15:
    buffer_load_dwordx4 v17, s[16:19], s90 offen offset:3072 nt lds
    s_add_u32 s90, s90, 4096
    s_xor_b32 s90, s90, 1048576
    s_add_u32 m0, m0, 4096
    s_cmp_lg_u32 s93, 0
    s_cbranch_scc1 fast_16
    ds_read_b32 v6, v10 offset:80
    s_waitcnt vmcnt(4)
    s_waitcnt lgkmcnt(0)
    v_cmp_eq_u32 vcc, 0, v6
    s_nop 0
    s_cmp_eq_u64 vcc, 0
    s_cselect_b32 s93, 1, 0
fast_16:
    buffer_load_dwordx4 v18, s[16:19], s90 offen offset:0 nt lds
    s_cmp_lg_u32 s93, 0
    s_cbranch_scc1 fast_17
    s_waitcnt vmcnt(4)
fast_17:
    buffer_load_dwordx4 v18, s[16:19], s90 offen offset:1024 nt lds
    s_cmp_lg_u32 s93, 0
    s_cbranch_scc1 fast_18
    ds_read_b32 v6, v10 offset:80
    s_waitcnt vmcnt(4)
    s_waitcnt lgkmcnt(0)
    v_cmp_eq_u32 vcc, 0, v6
    s_nop 0
    s_cmp_eq_u64 vcc, 0
    s_cselect_b32 s93, 1, 0
fast_18:
    buffer_load_dwordx4 v19, s[16:19], s90 offen offset:2048 nt lds
    s_cmp_lg_u32 s93, 0
    s_cbranch_scc1 fast_19
    s_waitcnt vmcnt(4)
fast_19:
    buffer_load_dwordx4 v19, s[16:19], s90 offen offset:3072 nt lds
    s_add_u32 s90, s90, 53248
    s_xor_b32 s90, s90, 524288
    s_add_u32 m0, m0, 4096
    s_cmp_lg_u32 s93, 0
    s_cbranch_scc1 fast_20
    ds_read_b32 v6, v10 offset:80
    s_waitcnt vmcnt(4)
    s_waitcnt lgkmcnt(0)
    v_cmp_eq_u32 vcc, 0, v6
    s_nop 0
    s_cmp_eq_u64 vcc, 0
    s_cselect_b32 s93, 1, 0
fast_20:
    buffer_load_dwordx4 v12, s[16:19], s90 offen offset:0 nt lds
    s_cmp_lg_u32 s93, 0
    s_cbranch_scc1 fast_21
    s_waitcnt vmcnt(4)
fast_21:
    buffer_load_dwordx4 v12, s[16:19], s90 offen offset:1024 nt lds
    s_cmp_lg_u32 s93, 0
    s_cbranch_scc1 fast_22
    ds_read_b32 v6, v10 offset:80
    s_waitcnt vmcnt(4)
    s_waitcnt lgkmcnt(0)
    v_cmp_eq_u32 vcc, 0, v6
    s_nop 0
    s_cmp_eq_u64 vcc, 0
    s_cselect_b32 s93, 1, 0
fast_22:
    buffer_load_dwordx4 v13, s[16:19], s90 offen offset:2048 nt lds
    s_cmp_lg_u32 s93, 0
    s_cbranch_scc1 fast_23
    s_waitcnt vmcnt(4)
fast_23:
    buffer_load_dwordx4 v13, s[16:19], s90 offen offset:3072 nt lds
    s_add_u32 s90, s90, 4096
    s_xor_b32 s90, s90, 1048576
    s_add_u32 m0, m0, 4096
    s_cmp_lg_u32 s93, 0
    s_cbranch_scc1 fast_24
    ds_read_b32 v6, v10 offset:80
    s_waitcnt vmcnt(4)
    s_waitcnt lgkmcnt(0)
    v_cmp_eq_u32 vcc, 0, v6
    s_nop 0
    s_cmp_eq_u64 vcc, 0
    s_cselect_b32 s93, 1, 0
fast_24:
    s_waitcnt lgkmcnt(0)
    s_add_u32 s56, s56, 0x9e3779b9
    v_mov_b32 v35, 0
    buffer_load_dwordx4 v14, s[16:19], s90 offen offset:0 nt lds
    s_cmp_lg_u32 s93, 0
    s_cbranch_scc1 fast_25
    s_waitcnt vmcnt(4)
fast_25:
    s_waitcnt vmcnt(19)
    s_waitcnt vmcnt(5)
    v_mov_b32 v5, 1
    ds_write_b32 v7, v5 offset:0
    buffer_load_dwordx4 v14, s[16:19], s90 offen offset:1024 nt lds
    s_cmp_lg_u32 s93, 0
    s_cbranch_scc1 fast_26
    ds_read_b32 v6, v10 offset:80
    s_waitcnt vmcnt(4)
    s_waitcnt lgkmcnt(0)
    v_cmp_eq_u32 vcc, 0, v6
    s_nop 0
    s_cmp_eq_u64 vcc, 0
    s_cselect_b32 s93, 1, 0
fast_26:
    buffer_load_dwordx4 v15, s[16:19], s90 offen offset:2048 nt lds
    s_cmp_lg_u32 s93, 0
    s_cbranch_scc1 fast_27
    s_waitcnt vmcnt(4)
fast_27:
    buffer_load_dwordx4 v15, s[16:19], s90 offen offset:3072 nt lds
    s_add_u32 s90, s90, 4096
    s_xor_b32 s90, s90, 524288
    s_add_u32 m0, m0, 4096
    s_cmp_lg_u32 s93, 0
    s_cbranch_scc1 fast_28
    ds_read_b32 v6, v10 offset:80
    s_waitcnt vmcnt(4)
    s_waitcnt lgkmcnt(0)
    v_cmp_eq_u32 vcc, 0, v6
    s_nop 0
    s_cmp_eq_u64 vcc, 0
    s_cselect_b32 s93, 1, 0
fast_28:
    buffer_load_dwordx4 v16, s[16:19], s90 offen offset:0 nt lds
    s_cmp_lg_u32 s93, 0
    s_cbranch_scc1 fast_29
    s_waitcnt vmcnt(4)
fast_29:
    buffer_load_dwordx4 v16, s[16:19], s90 offen offset:1024 nt lds
    s_cmp_lg_u32 s93, 0
    s_cbranch_scc1 fast_30
    ds_read_b32 v6, v10 offset:80
    s_waitcnt vmcnt(4)
    s_waitcnt lgkmcnt(0)
    v_cmp_eq_u32 vcc, 0, v6
    s_nop 0
    s_cmp_eq_u64 vcc, 0
    s_cselect_b32 s93, 1, 0
fast_30:
    buffer_load_dwordx4 v17, s[16:19], s90 offen offset:2048 nt lds
    s_cmp_lg_u32 s93, 0
    s_cbranch_scc1 fast_31
    s_waitcnt vmcnt(4)
fast_31:
    buffer_load_dwordx4 v17, s[16:19], s90 offen offset:3072 nt lds
    s_add_u32 s90, s90, 4096
    s_xor_b32 s90, s90, 1048576
    s_add_u32 m0, m0, 4096
    s_cmp_lg_u32 s93, 0
    s_cbranch_scc1 fast_32
    ds_read_b32 v6, v10 offset:80
    s_waitcnt vmcnt(4)
    s_waitcnt lgkmcnt(0)
    v_cmp_eq_u32 vcc, 0, v6
    s_nop 0
    s_cmp_eq_u64 vcc, 0
    s_cselect_b32 s93, 1, 0
fast_32:
    buffer_load_dwordx4 v18, s[16:19], s90 offen offset:0 nt lds
    s_cmp_lg_u32 s93, 0
    s_cbranch_scc1 fast_33
    s_waitcnt vmcnt(4)
fast_33:
    buffer_load_dwordx4 v18, s[16:19], s90 offen offset:1024 nt lds
    s_cmp_lg_u32 s93, 0
    s_cbranch_scc1 fast_34
    ds_read_b32 v6, v10 offset:80
    s_waitcnt vmcnt(4)
    s_waitcnt lgkmcnt(0)
    v_cmp_eq_u32 vcc, 0, v6
    s_nop 0
    s_cmp_eq_u64 vcc, 0
    s_cselect_b32 s93, 1, 0
fast_34:
    buffer_load_dwordx4 v19, s[16:19], s90 offen offset:2048 nt lds
    s_add_u32 s90, s90, 53248
    s_xor_b32 s90, s90, 524288
    s_add_u32 m0, m0, 4096
    s_cmp_lg_u32 s93, 0
    s_cbranch_scc1 fast_35
    s_waitcnt vmcnt(4)
fast_35:
    buffer_load_dwordx4 v[128:131], v12, s[16:19], s90 offen offset:0 nt
    s_cmp_lg_u32 s93, 0
    s_cbranch_scc1 fast_36
    ds_read_b32 v6, v10 offset:80
    s_waitcnt vmcnt(4)
    s_waitcnt lgkmcnt(0)
    v_cmp_eq_u32 vcc, 0, v6
    s_nop 0
    s_cmp_eq_u64 vcc, 0
    s_cselect_b32 s93, 1, 0
fast_36:
    buffer_load_dwordx4 v[132:135], v12, s[16:19], s90 offen offset:1024 nt
    s_cmp_lg_u32 s93, 0
    s_cbranch_scc1 fast_37
    s_waitcnt vmcnt(4)
fast_37:
    buffer_load_dwordx4 v[136:139], v13, s[16:19], s90 offen offset:2048 nt
    s_cmp_lg_u32 s93, 0
    s_cbranch_scc1 fast_38
    ds_read_b32 v6, v10 offset:80
    s_waitcnt vmcnt(4)
    s_waitcnt lgkmcnt(0)
    v_cmp_eq_u32 vcc, 0, v6
    s_nop 0
    s_cmp_eq_u64 vcc, 0
    s_cselect_b32 s93, 1, 0
fast_38:
    buffer_load_dwordx4 v[140:143], v13, s[16:19], s90 offen offset:3072 nt
    s_add_u32 s90, s90, 4096
    s_xor_b32 s90, s90, 1048576
    s_cmp_lg_u32 s93, 0
    s_cbranch_scc1 fast_39
    s_waitcnt vmcnt(4)
fast_39:
    buffer_load_dwordx4 v[144:147], v14, s[16:19], s90 offen offset:0 nt
    s_cmp_lg_u32 s93, 0
    s_cbranch_scc1 fast_40
    ds_read_b32 v6, v10 offset:80
    s_waitcnt vmcnt(4)
    s_waitcnt lgkmcnt(0)
    v_cmp_eq_u32 vcc, 0, v6
    s_nop 0
    s_cmp_eq_u64 vcc, 0
    s_cselect_b32 s93, 1, 0
fast_40:
    s_waitcnt vmcnt(19)
    buffer_load_dwordx4 v[148:151], v14, s[16:19], s90 offen offset:1024 nt
    s_cmp_lg_u32 s93, 0
    s_cbranch_scc1 fast_41
    s_waitcnt vmcnt(4)
fast_41:
    s_waitcnt vmcnt(19)
    buffer_load_dwordx4 v[152:155], v15, s[16:19], s90 offen offset:2048 nt
    s_cmp_lg_u32 s93, 0
    s_cbranch_scc1 fast_42
    ds_read_b32 v6, v10 offset:80
    s_waitcnt vmcnt(4)
    s_waitcnt lgkmcnt(0)
    v_cmp_eq_u32 vcc, 0, v6
    s_nop 0
    s_cmp_eq_u64 vcc, 0
    s_cselect_b32 s93, 1, 0
fast_42:
    s_waitcnt vmcnt(19)
    buffer_load_dwordx4 v[156:159], v15, s[16:19], s90 offen offset:3072 nt
    s_add_u32 s90, s90, 4096
    s_xor_b32 s90, s90, 524288
    s_cmp_lg_u32 s93, 0
    s_cbranch_scc1 fast_43
    s_waitcnt vmcnt(4)
fast_43:
    s_waitcnt vmcnt(19)
    buffer_load_dwordx4 v[160:163], v16, s[16:19], s90 offen offset:0 nt
    s_cmp_lg_u32 s93, 0
    s_cbranch_scc1 fast_44
    ds_read_b32 v6, v10 offset:80
    s_waitcnt vmcnt(4)
    s_waitcnt lgkmcnt(0)
    v_cmp_eq_u32 vcc, 0, v6
    s_nop 0
    s_cmp_eq_u64 vcc, 0
    s_cselect_b32 s93, 1, 0
fast_44:
    s_waitcnt vmcnt(19)
    buffer_load_dwordx4 v[164:167], v16, s[16:19], s90 offen offset:1024 nt
    s_cmp_lg_u32 s93, 0
    s_cbranch_scc1 fast_45
    s_waitcnt vmcnt(4)
fast_45:
    s_waitcnt vmcnt(19)
    buffer_load_dwordx4 v[168:171], v17, s[16:19], s90 offen offset:2048 nt
    s_cmp_lg_u32 s93, 0
    s_cbranch_scc1 fast_46
    ds_read_b32 v6, v10 offset:80
    s_waitcnt vmcnt(4)
    s_waitcnt lgkmcnt(0)
    v_cmp_eq_u32 vcc, 0, v6
    s_nop 0
    s_cmp_eq_u64 vcc, 0
    s_cselect_b32 s93, 1, 0
fast_46:
    s_waitcnt vmcnt(19)
    buffer_load_dwordx4 v[172:175], v17, s[16:19], s90 offen offset:3072 nt
    s_add_u32 s90, s90, 4096
    s_xor_b32 s90, s90, 1048576
    s_cmp_lg_u32 s93, 0
    s_cbranch_scc1 fast_47
    s_waitcnt vmcnt(4)
fast_47:
    s_waitcnt vmcnt(19)
    s_waitcnt vmcnt(12)
    v_mov_b32 v5, 2
    ds_write_b32 v7, v5 offset:0
    buffer_load_dwordx4 v[176:179], v18, s[16:19], s90 offen offset:0 nt
    s_cmp_lg_u32 s93, 0
    s_cbranch_scc1 fast_48
    ds_read_b32 v6, v10 offset:80
    s_waitcnt vmcnt(4)
    s_waitcnt lgkmcnt(0)
    v_cmp_eq_u32 vcc, 0, v6
    s_nop 0
    s_cmp_eq_u64 vcc, 0
    s_cselect_b32 s93, 1, 0
fast_48:
    buffer_load_dwordx4 v[180:183], v18, s[16:19], s90 offen offset:1024 nt
    s_cmp_lg_u32 s93, 0
    s_cbranch_scc1 fast_49
    s_waitcnt vmcnt(4)
fast_49:
    buffer_load_dwordx4 v[184:187], v19, s[16:19], s90 offen offset:2048 nt
    s_cmp_lg_u32 s93, 0
    s_cbranch_scc1 fast_50
    ds_read_b32 v6, v10 offset:80
    s_waitcnt vmcnt(4)
    s_waitcnt lgkmcnt(0)
    v_cmp_eq_u32 vcc, 0, v6
    s_nop 0
    s_cmp_eq_u64 vcc, 0
    s_cselect_b32 s93, 1, 0
fast_50:
    buffer_load_dwordx4 v[188:191], v19, s[16:19], s90 offen offset:3072 nt
    s_add_u32 s90, s90, 53248
    s_xor_b32 s90, s90, 524288
    s_cmp_lg_u32 s93, 0
    s_cbranch_scc1 fast_51
    s_waitcnt vmcnt(4)
fast_51:
    buffer_load_dwordx4 v[192:195], v12, s[16:19], s90 offen offset:0 nt
    s_cmp_lg_u32 s93, 0
    s_cbranch_scc1 fast_52
    ds_read_b32 v6, v10 offset:80
    s_waitcnt vmcnt(4)
    s_waitcnt lgkmcnt(0)
    v_cmp_eq_u32 vcc, 0, v6
    s_nop 0
    s_cmp_eq_u64 vcc, 0
    s_cselect_b32 s93, 1, 0
fast_52:
    buffer_load_dwordx4 v[196:199], v12, s[16:19], s90 offen offset:1024 nt
    s_cmp_lg_u32 s93, 0
    s_cbranch_scc1 fast_53
    s_waitcnt vmcnt(4)
fast_53:
    buffer_load_dwordx4 v[200:203], v13, s[16:19], s90 offen offset:2048 nt
    s_cmp_lg_u32 s93, 0
    s_cbranch_scc1 fast_54
    ds_read_b32 v6, v10 offset:80
    s_waitcnt vmcnt(4)
    s_waitcnt lgkmcnt(0)
    v_cmp_eq_u32 vcc, 0, v6
    s_nop 0
    s_cmp_eq_u64 vcc, 0
    s_cselect_b32 s93, 1, 0
fast_54:
    buffer_load_dwordx4 v[204:207], v13, s[16:19], s90 offen offset:3072 nt
    s_add_u32 s90, s90, 4096
    s_xor_b32 s90, s90, 1048576
    s_mov_b32 s60, 8000000
    s_mov_b32 s95, 2
L_pp0:
    ds_read_b32 v34, v10 offset:96
    s_waitcnt lgkmcnt(0)
    v_cmp_ne_u32 vcc, s95, v34
    s_nop 3
    s_cbranch_vccnz L_ps0
L_pg0:
    ds_read_b128 v[36:39], v28 offset:0
    ds_read_b64_tr_b16 v[44:45], v20 offset:0
    ds_read_b64_tr_b16 v[46:47], v20 offset:1024
    ds_read_b64_tr_b16 v[48:49], v21 offset:0
    ds_read_b64_tr_b16 v[50:51], v21 offset:1024
    ds_read_b128 v[40:43], v28 offset:1024
    ds_read_b64_tr_b16 v[52:53], v22 offset:0
    ds_read_b64_tr_b16 v[54:55], v22 offset:1024
    ds_read_b64_tr_b16 v[56:57], v23 offset:0
    ds_read_b64_tr_b16 v[58:59], v23 offset:1024
    ds_read_b64_tr_b16 v[60:61], v20 offset:32768
    ds_read_b64_tr_b16 v[62:63], v20 offset:33792
    ds_read_b64_tr_b16 v[12:13], v21 offset:32768
    ds_read_b64_tr_b16 v[14:15], v21 offset:33792
    s_waitcnt lgkmcnt(11)
    v_mfma_f32_32x32x16_bf16 v[64:79], v[36:39], v[44:47], 0
    ds_read_b64_tr_b16 v[16:17], v22 offset:32768
    ds_read_b64_tr_b16 v[18:19], v22 offset:33792
    s_waitcnt lgkmcnt(11)
    v_mfma_f32_32x32x16_bf16 v[80:95], v[36:39], v[48:51], 0
    v_add_u32 v35, 1, v35
    ds_read_b64_tr_b16 v[44:45], v23 offset:32768
    ds_read_b64_tr_b16 v[46:47], v23 offset:33792
    s_waitcnt lgkmcnt(10)
    v_mfma_f32_32x32x16_bf16 v[96:111], v[36:39], v[52:55], 0
    ds_read_b64_tr_b16 v[48:49], v24 offset:0
    ds_read_b64_tr_b16 v[50:51], v24 offset:1024
    s_waitcnt lgkmcnt(10)
    ds_write_b32 v7, v35 offset:48
    v_mfma_f32_32x32x16_bf16 v[112:127], v[36:39], v[56:59], 0
    ds_read_b128 v[36:39], v28 offset:2048
    ds_read_b64_tr_b16 v[52:53], v25 offset:0
    ds_read_b64_tr_b16 v[54:55], v25 offset:1024
    s_waitcnt lgkmcnt(12)
    v_mfma_f32_32x32x16_bf16 v[64:79], v[40:43], v[60:63], v[64:79]
    ds_read_b64_tr_b16 v[56:57], v26 offset:0
    ds_read_b64_tr_b16 v[58:59], v26 offset:1024
    s_waitcnt lgkmcnt(12)
    v_mfma_f32_32x32x16_bf16 v[80:95], v[40:43], v[12:15], v[80:95]
    v_add_u32 v35, 1, v35
    ds_read_b64_tr_b16 v[60:61], v27 offset:0
    ds_read_b64_tr_b16 v[62:63], v27 offset:1024
    s_waitcnt lgkmcnt(12)
    v_mfma_f32_32x32x16_bf16 v[96:111], v[40:43], v[16:19], v[96:111]
    ds_read_b64_tr_b16 v[12:13], v24 offset:32768
    ds_read_b64_tr_b16 v[14:15], v24 offset:33792
    s_waitcnt lgkmcnt(12)
    ds_write_b32 v7, v35 offset:48
    v_mfma_f32_32x32x16_bf16 v[112:127], v[40:43], v[44:47], v[112:127]
    ds_read_b128 v[40:43], v28 offset:3072
    ds_read_b64_tr_b16 v[16:17], v25 offset:32768
    ds_read_b64_tr_b16 v[18:19], v25 offset:33792
    s_waitcnt lgkmcnt(12)
    v_mfma_f32_32x32x16_bf16 v[64:79], v[36:39], v[48:51], v[64:79]
    ds_read_b64_tr_b16 v[44:45], v26 offset:32768
    ds_read_b64_tr_b16 v[46:47], v26 offset:33792
    s_waitcnt lgkmcnt(12)
    v_mfma_f32_32x32x16_bf16 v[80:95], v[36:39], v[52:55], v[80:95]
    v_add_u32 v35, 1, v35
    ds_read_b64_tr_b16 v[48:49], v27 offset:32768
    ds_read_b64_tr_b16 v[50:51], v27 offset:33792
    s_waitcnt lgkmcnt(12)
    v_mfma_f32_32x32x16_bf16 v[96:111], v[36:39], v[56:59], v[96:111]
    s_waitcnt lgkmcnt(10)
    ds_write_b32 v7, v35 offset:48
    v_mfma_f32_32x32x16_bf16 v[112:127], v[36:39], v[60:63], v[112:127]
    s_waitcnt lgkmcnt(7)
    v_mfma_f32_32x32x16_bf16 v[64:79], v[40:43], v[12:15], v[64:79]
    s_waitcnt lgkmcnt(5)
    v_mfma_f32_32x32x16_bf16 v[80:95], v[40:43], v[16:19], v[80:95]
    v_add_u32 v35, 1, v35
    s_waitcnt lgkmcnt(3)
    v_mfma_f32_32x32x16_bf16 v[96:111], v[40:43], v[44:47], v[96:111]
    s_waitcnt lgkmcnt(1)
    ds_write_b32 v7, v35 offset:48
    v_mfma_f32_32x32x16_bf16 v[112:127], v[40:43], v[48:51], v[112:127]
    s_mov_b32 s60, 8000000
    s_mov_b32 s95, 2
L_pp1:
    ds_read_b32 v34, v10 offset:112
    s_waitcnt lgkmcnt(0)
    v_cmp_ne_u32 vcc, s95, v34
    s_nop 5
    s_cbranch_vccnz L_ps1
L_pg1:
    ds_read_b128 v[36:39], v28 offset:4096
    ds_read_b64_tr_b16 v[44:45], v20 offset:16384
    ds_read_b64_tr_b16 v[46:47], v20 offset:17408
    ds_read_b64_tr_b16 v[48:49], v21 offset:16384
    ds_read_b64_tr_b16 v[50:51], v21 offset:17408
    ds_read_b128 v[40:43], v28 offset:5120
    ds_read_b64_tr_b16 v[52:53], v22 offset:16384
    ds_read_b64_tr_b16 v[54:55], v22 offset:17408
    ds_read_b64_tr_b16 v[56:57], v23 offset:16384
    ds_read_b64_tr_b16 v[58:59], v23 offset:17408
    ds_read_b64_tr_b16 v[60:61], v20 offset:49152
    ds_read_b64_tr_b16 v[62:63], v20 offset:50176
    ds_read_b64_tr_b16 v[12:13], v21 offset:49152
    ds_read_b64_tr_b16 v[14:15], v21 offset:50176
    s_waitcnt lgkmcnt(11)
    v_mfma_f32_32x32x16_bf16 v[64:79], v[36:39], v[44:47], v[64:79]
    ds_read_b64_tr_b16 v[16:17], v22 offset:49152
    ds_read_b64_tr_b16 v[18:19], v22 offset:50176
    s_waitcnt lgkmcnt(11)
    v_mfma_f32_32x32x16_bf16 v[80:95], v[36:39], v[48:51], v[80:95]
    ds_read_b64_tr_b16 v[44:45], v23 offset:49152
    ds_read_b64_tr_b16 v[46:47], v23 offset:50176
    s_waitcnt lgkmcnt(10)
    v_mfma_f32_32x32x16_bf16 v[96:111], v[36:39], v[52:55], v[96:111]
    ds_read_b64_tr_b16 v[48:49], v24 offset:16384
    ds_read_b64_tr_b16 v[50:51], v24 offset:17408
    s_waitcnt lgkmcnt(10)
    v_mfma_f32_32x32x16_bf16 v[112:127], v[36:39], v[56:59], v[112:127]
    ds_read_b128 v[36:39], v28 offset:6144
    ds_read_b64_tr_b16 v[52:53], v25 offset:16384
    ds_read_b64_tr_b16 v[54:55], v25 offset:17408
    s_waitcnt lgkmcnt(11)
    v_mfma_f32_32x32x16_bf16 v[64:79], v[40:43], v[60:63], v[64:79]
    ds_read_b64_tr_b16 v[56:57], v26 offset:16384
    ds_read_b64_tr_b16 v[58:59], v26 offset:17408
    s_waitcnt lgkmcnt(11)
    v_mfma_f32_32x32x16_bf16 v[80:95], v[40:43], v[12:15], v[80:95]
    ds_read_b64_tr_b16 v[60:61], v27 offset:16384
    ds_read_b64_tr_b16 v[62:63], v27 offset:17408
    s_waitcnt lgkmcnt(11)
    v_mfma_f32_32x32x16_bf16 v[96:111], v[40:43], v[16:19], v[96:111]
    ds_read_b64_tr_b16 v[12:13], v24 offset:49152
    ds_read_b64_tr_b16 v[14:15], v24 offset:50176
    s_waitcnt lgkmcnt(11)
    v_mfma_f32_32x32x16_bf16 v[112:127], v[40:43], v[44:47], v[112:127]
    ds_read_b128 v[40:43], v28 offset:7168
    ds_read_b64_tr_b16 v[16:17], v25 offset:49152
    ds_read_b64_tr_b16 v[18:19], v25 offset:50176
    s_waitcnt lgkmcnt(11)
    v_mfma_f32_32x32x16_bf16 v[64:79], v[36:39], v[48:51], v[64:79]
    ds_read_b64_tr_b16 v[44:45], v26 offset:49152
    ds_read_b64_tr_b16 v[46:47], v26 offset:50176
    s_waitcnt lgkmcnt(11)
    v_mfma_f32_32x32x16_bf16 v[80:95], v[36:39], v[52:55], v[80:95]
    ds_read_b64_tr_b16 v[48:49], v27 offset:49152
    ds_read_b64_tr_b16 v[50:51], v27 offset:50176
    s_waitcnt lgkmcnt(11)
    v_mfma_f32_32x32x16_bf16 v[96:111], v[36:39], v[56:59], v[96:111]
    s_waitcnt lgkmcnt(9)
    v_mfma_f32_32x32x16_bf16 v[112:127], v[36:39], v[60:63], v[112:127]
    s_waitcnt lgkmcnt(6)
    v_mfma_f32_32x32x16_bf16 v[64:79], v[40:43], v[12:15], v[64:79]
    s_waitcnt lgkmcnt(4)
    v_mfma_f32_32x32x16_bf16 v[80:95], v[40:43], v[16:19], v[80:95]
    s_waitcnt lgkmcnt(2)
    v_mfma_f32_32x32x16_bf16 v[96:111], v[40:43], v[44:47], v[96:111]
    s_waitcnt lgkmcnt(0)
    v_mfma_f32_32x32x16_bf16 v[112:127], v[40:43], v[48:51], v[112:127]
    v_mov_b32 v5, 5
    ds_write_b32 v7, v5 offset:48
    s_mov_b32 s60, 8000000
lw_55:
    ds_read_b32 v5, v10 offset:48
    s_waitcnt lgkmcnt(0)
    v_cmp_gt_u32 vcc, 5, v5
    s_nop 4
    s_cbranch_vccz lwd_56
    s_sub_u32 s60, s60, 1
    s_cbranch_scc0 lw_55
lwd_56:
    s_waitcnt vmcnt(18)
    ds_write_b128 v9, v[128:131] offset:16384
    ds_write_b128 v9, v[132:135] offset:17408
    s_waitcnt vmcnt(16)
    ds_write_b128 v9, v[136:139] offset:18432
    ds_write_b128 v9, v[140:143] offset:19456
    s_waitcnt vmcnt(14)
    ds_write_b128 v9, v[144:147] offset:20480
    ds_write_b128 v9, v[148:151] offset:21504
    s_waitcnt vmcnt(12)
    ds_write_b128 v9, v[152:155] offset:22528
    ds_write_b128 v9, v[156:159] offset:23552
    s_waitcnt vmcnt(10)
    ds_write_b128 v9, v[160:163] offset:24576
    ds_write_b128 v9, v[164:167] offset:25600
    s_waitcnt vmcnt(8)
    ds_write_b128 v9, v[168:171] offset:26624
    ds_write_b128 v9, v[172:175] offset:27648
    s_waitcnt vmcnt(6)
    ds_write_b128 v9, v[176:179] offset:28672
    ds_write_b128 v9, v[180:183] offset:29696
    s_waitcnt vmcnt(4)
    ds_write_b128 v9, v[184:187] offset:30720
    ds_write_b128 v9, v[188:191] offset:31744
    v_mov_b32 v5, 3
    ds_write_b32 v7, v5 offset:0
    s_waitcnt vmcnt(2)
    ds_write_b128 v9, v[192:195] offset:0
    ds_write_b128 v9, v[196:199] offset:1024
    s_waitcnt vmcnt(0)
    ds_write_b128 v9, v[200:203] offset:2048
    ds_write_b128 v9, v[204:207] offset:3072
    v_mov_b32 v5, 4
    ds_write_b32 v7, v5 offset:0
    s_mov_b32 s60, 8000000
    s_mov_b32 s95, 2
L_pp2:
    ds_read_b32 v34, v10 offset:128
    s_waitcnt lgkmcnt(0)
    v_cmp_ne_u32 vcc, s95, v34
    s_nop 3
    s_cbranch_vccnz L_ps2
L_pg2:
    ds_read_b128 v[36:39], v28 offset:8192
    ds_read_b64_tr_b16 v[44:45], v20 offset:16384
    ds_read_b64_tr_b16 v[46:47], v20 offset:17408
    ds_read_b64_tr_b16 v[48:49], v21 offset:16384
    ds_read_b64_tr_b16 v[50:51], v21 offset:17408
    ds_read_b128 v[40:43], v28 offset:9216
    ds_read_b64_tr_b16 v[52:53], v22 offset:16384
    ds_read_b64_tr_b16 v[54:55], v22 offset:17408
    ds_read_b64_tr_b16 v[56:57], v23 offset:16384
    ds_read_b64_tr_b16 v[58:59], v23 offset:17408
    ds_read_b64_tr_b16 v[60:61], v20 offset:49152
    ds_read_b64_tr_b16 v[62:63], v20 offset:50176
    ds_read_b64_tr_b16 v[12:13], v21 offset:49152
    ds_read_b64_tr_b16 v[14:15], v21 offset:50176
    s_waitcnt lgkmcnt(11)
    v_mfma_f32_32x32x16_bf16 v[64:79], v[36:39], v[44:47], v[64:79]
    ds_read_b64_tr_b16 v[16:17], v22 offset:49152
    ds_read_b64_tr_b16 v[18:19], v22 offset:50176
    s_waitcnt lgkmcnt(11)
    v_mfma_f32_32x32x16_bf16 v[80:95], v[36:39], v[48:51], v[80:95]
    ds_read_b64_tr_b16 v[44:45], v23 offset:49152
    ds_read_b64_tr_b16 v[46:47], v23 offset:50176
    s_waitcnt lgkmcnt(10)
    v_mfma_f32_32x32x16_bf16 v[96:111], v[36:39], v[52:55], v[96:111]
    ds_read_b64_tr_b16 v[48:49], v24 offset:16384
    ds_read_b64_tr_b16 v[50:51], v24 offset:17408
    s_waitcnt lgkmcnt(10)
    v_mfma_f32_32x32x16_bf16 v[112:127], v[36:39], v[56:59], v[112:127]
    ds_read_b128 v[36:39], v28 offset:10240
    ds_read_b64_tr_b16 v[52:53], v25 offset:16384
    ds_read_b64_tr_b16 v[54:55], v25 offset:17408
    s_waitcnt lgkmcnt(11)
    v_mfma_f32_32x32x16_bf16 v[64:79], v[40:43], v[60:63], v[64:79]
    ds_read_b64_tr_b16 v[56:57], v26 offset:16384
    ds_read_b64_tr_b16 v[58:59], v26 offset:17408
    s_waitcnt lgkmcnt(11)
    v_mfma_f32_32x32x16_bf16 v[80:95], v[40:43], v[12:15], v[80:95]
    ds_read_b64_tr_b16 v[60:61], v27 offset:16384
    ds_read_b64_tr_b16 v[62:63], v27 offset:17408
    s_waitcnt lgkmcnt(11)
    v_mfma_f32_32x32x16_bf16 v[96:111], v[40:43], v[16:19], v[96:111]
    ds_read_b64_tr_b16 v[12:13], v24 offset:49152
    ds_read_b64_tr_b16 v[14:15], v24 offset:50176
    s_waitcnt lgkmcnt(11)
    v_mfma_f32_32x32x16_bf16 v[112:127], v[40:43], v[44:47], v[112:127]
    ds_read_b128 v[40:43], v28 offset:11264
    ds_read_b64_tr_b16 v[16:17], v25 offset:49152
    ds_read_b64_tr_b16 v[18:19], v25 offset:50176
    s_waitcnt lgkmcnt(11)
    v_mfma_f32_32x32x16_bf16 v[64:79], v[36:39], v[48:51], v[64:79]
    ds_read_b64_tr_b16 v[44:45], v26 offset:49152
    ds_read_b64_tr_b16 v[46:47], v26 offset:50176
    s_waitcnt lgkmcnt(11)
    v_mfma_f32_32x32x16_bf16 v[80:95], v[36:39], v[52:55], v[80:95]
    ds_read_b64_tr_b16 v[48:49], v27 offset:49152
    ds_read_b64_tr_b16 v[50:51], v27 offset:50176
    s_waitcnt lgkmcnt(11)
    v_mfma_f32_32x32x16_bf16 v[96:111], v[36:39], v[56:59], v[96:111]
    s_waitcnt lgkmcnt(9)
    v_mfma_f32_32x32x16_bf16 v[112:127], v[36:39], v[60:63], v[112:127]
    s_waitcnt lgkmcnt(6)
    v_mfma_f32_32x32x16_bf16 v[64:79], v[40:43], v[12:15], v[64:79]
    s_waitcnt lgkmcnt(4)
    v_mfma_f32_32x32x16_bf16 v[80:95], v[40:43], v[16:19], v[80:95]
    s_waitcnt lgkmcnt(2)
    v_mfma_f32_32x32x16_bf16 v[96:111], v[40:43], v[44:47], v[96:111]
    s_waitcnt lgkmcnt(0)
    v_mfma_f32_32x32x16_bf16 v[112:127], v[40:43], v[48:51], v[112:127]
    v_mov_b32 v35, 6
    s_mov_b32 s60, 8000000
    s_mov_b32 s95, 2
L_pp3:
    ds_read_b32 v34, v10 offset:144
    s_waitcnt lgkmcnt(0)
    v_cmp_ne_u32 vcc, s95, v34
    s_nop 4
    s_cbranch_vccnz L_ps3
L_pg3:
    ds_read_b128 v[192:195], v28 offset:12288
    ds_read_b64_tr_b16 v[44:45], v20 offset:0
    ds_read_b64_tr_b16 v[46:47], v20 offset:1024
    ds_read_b64_tr_b16 v[48:49], v21 offset:0
    ds_read_b64_tr_b16 v[50:51], v21 offset:1024
    ds_read_b128 v[196:199], v28 offset:13312
    ds_read_b64_tr_b16 v[52:53], v20 offset:32768
    ds_read_b64_tr_b16 v[54:55], v20 offset:33792
    ds_read_b64_tr_b16 v[56:57], v21 offset:32768
    ds_read_b64_tr_b16 v[58:59], v21 offset:33792
    ds_read_b64_tr_b16 v[60:61], v24 offset:0
    ds_read_b64_tr_b16 v[62:63], v24 offset:1024
    ds_read_b64_tr_b16 v[12:13], v25 offset:0
    ds_read_b64_tr_b16 v[14:15], v25 offset:1024
    s_waitcnt lgkmcnt(11)
    v_mfma_f32_32x32x16_bf16 v[64:79], v[192:195], v[44:47], v[64:79]
    ds_read_b128 v[200:203], v28 offset:14336
    ds_read_b64_tr_b16 v[16:17], v24 offset:32768
    ds_read_b64_tr_b16 v[18:19], v24 offset:33792
    s_waitcnt lgkmcnt(12)
    v_mfma_f32_32x32x16_bf16 v[80:95], v[192:195], v[48:51], v[80:95]
    ds_read_b128 v[204:207], v28 offset:15360
    ds_read_b64_tr_b16 v[44:45], v25 offset:32768
    ds_read_b64_tr_b16 v[46:47], v25 offset:33792
    s_waitcnt lgkmcnt(12)
    v_mfma_f32_32x32x16_bf16 v[64:79], v[196:199], v[52:55], v[64:79]
    ds_read_b64_tr_b16 v[48:49], v22 offset:0
    ds_read_b64_tr_b16 v[50:51], v22 offset:1024
    s_waitcnt lgkmcnt(12)
    v_mfma_f32_32x32x16_bf16 v[80:95], v[196:199], v[56:59], v[80:95]
    ds_read_b64_tr_b16 v[52:53], v23 offset:0
    ds_read_b64_tr_b16 v[54:55], v23 offset:1024
    s_waitcnt lgkmcnt(9)
    v_mfma_f32_32x32x16_bf16 v[64:79], v[200:203], v[60:63], v[64:79]
    ds_read_b64_tr_b16 v[56:57], v22 offset:32768
    ds_read_b64_tr_b16 v[58:59], v22 offset:33792
    s_waitcnt lgkmcnt(11)
    v_mfma_f32_32x32x16_bf16 v[80:95], v[200:203], v[12:15], v[80:95]
    ds_read_b64_tr_b16 v[60:61], v23 offset:32768
    ds_read_b64_tr_b16 v[62:63], v23 offset:33792
    s_waitcnt lgkmcnt(10)
    v_mfma_f32_32x32x16_bf16 v[64:79], v[204:207], v[16:19], v[64:79]
    ds_read_b64_tr_b16 v[12:13], v26 offset:0
    ds_read_b64_tr_b16 v[14:15], v26 offset:1024
    s_waitcnt lgkmcnt(10)
    v_mfma_f32_32x32x16_bf16 v[80:95], v[204:207], v[44:47], v[80:95]
    ds_read_b64_tr_b16 v[16:17], v27 offset:0
    ds_read_b64_tr_b16 v[18:19], v27 offset:1024
    s_waitcnt lgkmcnt(10)
    v_mfma_f32_32x32x16_bf16 v[96:111], v[192:195], v[48:51], v[96:111]
    ds_read_b64_tr_b16 v[44:45], v26 offset:32768
    ds_read_b64_tr_b16 v[46:47], v26 offset:33792
    s_waitcnt lgkmcnt(10)
    v_mfma_f32_32x32x16_bf16 v[112:127], v[192:195], v[52:55], v[112:127]
    ds_read_b64_tr_b16 v[48:49], v27 offset:32768
    ds_read_b64_tr_b16 v[50:51], v27 offset:33792
    s_waitcnt lgkmcnt(10)
    v_mfma_f32_32x32x16_bf16 v[96:111], v[196:199], v[56:59], v[96:111]
    v_cvt_pk_bf16_f32 v128, v64, v80
    v_cvt_pk_bf16_f32 v129, v65, v81
    v_cvt_pk_bf16_f32 v132, v66, v82
    v_cvt_pk_bf16_f32 v133, v67, v83
    s_add_u32 s92, s96, 0
    v_permlane16_swap_b32 v128, v129
    s_waitcnt lgkmcnt(8)
    v_mfma_f32_32x32x16_bf16 v[112:127], v[196:199], v[60:63], v[112:127]
    buffer_store_dwordx2 v[128:129], v29, s[12:15], s92 offen offset:0 sc1
    v_xor_b32 v160, v128, v129
    v_cvt_pk_bf16_f32 v136, v68, v84
    v_cvt_pk_bf16_f32 v137, v69, v85
    s_add_u32 s92, s96, 262144
    v_permlane16_swap_b32 v132, v133
    s_waitcnt lgkmcnt(6)
    v_mfma_f32_32x32x16_bf16 v[96:111], v[200:203], v[12:15], v[96:111]
    buffer_store_dwordx2 v[132:133], v29, s[12:15], s92 offen offset:0 sc1
    v_xor_b32 v161, v132, v133
    v_cvt_pk_bf16_f32 v140, v70, v86
    v_cvt_pk_bf16_f32 v141, v71, v87
    s_add_u32 s92, s96, 1048576
    v_permlane16_swap_b32 v136, v137
    s_waitcnt lgkmcnt(4)
    v_mfma_f32_32x32x16_bf16 v[112:127], v[200:203], v[16:19], v[112:127]
    buffer_store_dwordx2 v[136:137], v29, s[12:15], s92 offen offset:0 sc1
    v_xor_b32 v162, v136, v137
    v_cvt_pk_bf16_f32 v144, v72, v88
    v_cvt_pk_bf16_f32 v145, v73, v89
    s_add_u32 s92, s96, 1310720
    v_permlane16_swap_b32 v140, v141
    s_waitcnt lgkmcnt(2)
    v_mfma_f32_32x32x16_bf16 v[96:111], v[204:207], v[44:47], v[96:111]
    buffer_store_dwordx2 v[140:141], v29, s[12:15], s92 offen offset:0 sc1
    v_xor_b32 v163, v140, v141
    v_cvt_pk_bf16_f32 v148, v74, v90
    v_cvt_pk_bf16_f32 v149, v75, v91
    s_add_u32 s92, s96, 2097152
    v_permlane16_swap_b32 v144, v145
    s_waitcnt lgkmcnt(0)
    v_mfma_f32_32x32x16_bf16 v[112:127], v[204:207], v[48:51], v[112:127]
    buffer_store_dwordx2 v[144:145], v29, s[12:15], s92 offen offset:0 sc1
    v_xor_b32 v164, v144, v145
    v_cvt_pk_bf16_f32 v152, v76, v92
    v_cvt_pk_bf16_f32 v153, v77, v93
    s_add_u32 s92, s96, 2359296
    v_permlane16_swap_b32 v148, v149
    buffer_store_dwordx2 v[148:149], v29, s[12:15], s92 offen offset:0 sc1
    v_xor_b32 v165, v148, v149
    v_cvt_pk_bf16_f32 v156, v78, v94
    v_cvt_pk_bf16_f32 v157, v79, v95
    s_add_u32 s92, s96, 3145728
    v_permlane16_swap_b32 v152, v153
    buffer_store_dwordx2 v[152:153], v29, s[12:15], s92 offen offset:0 sc1
    v_xor_b32 v166, v152, v153
    s_add_u32 s92, s96, 3407872
    v_permlane16_swap_b32 v156, v157
    buffer_store_dwordx2 v[156:157], v29, s[12:15], s92 offen offset:0 sc1
    v_xor_b32 v167, v156, v157
    ds_read_b32 v34, v10 offset:64
    ds_read_b128 v[172:175], v32
    ds_read_b32 v168, v31
    v_cvt_pk_bf16_f32 v130, v96, v112
    v_cvt_pk_bf16_f32 v131, v97, v113
    v_cvt_pk_bf16_f32 v134, v98, v114
    v_cvt_pk_bf16_f32 v135, v99, v115
    s_add_u32 s92, s96, 0
    v_permlane16_swap_b32 v130, v131
    buffer_store_dwordx2 v[130:131], v29, s[12:15], s92 offen offset:128 sc1
    v_bitop3_b32 v160, v160, v130, v131 bitop3:0x96
    v_cvt_pk_bf16_f32 v138, v100, v116
    v_cvt_pk_bf16_f32 v139, v101, v117
    s_add_u32 s92, s96, 262144
    v_permlane16_swap_b32 v134, v135
    buffer_store_dwordx2 v[134:135], v29, s[12:15], s92 offen offset:128 sc1
    v_bitop3_b32 v161, v161, v134, v135 bitop3:0x96
    v_cvt_pk_bf16_f32 v142, v102, v118
    v_cvt_pk_bf16_f32 v143, v103, v119
    s_add_u32 s92, s96, 1048576
    v_permlane16_swap_b32 v138, v139
    buffer_store_dwordx2 v[138:139], v29, s[12:15], s92 offen offset:128 sc1
    v_bitop3_b32 v162, v162, v138, v139 bitop3:0x96
    v_cvt_pk_bf16_f32 v146, v104, v120
    v_cvt_pk_bf16_f32 v147, v105, v121
    s_add_u32 s92, s96, 1310720
    v_permlane16_swap_b32 v142, v143
    buffer_store_dwordx2 v[142:143], v29, s[12:15], s92 offen offset:128 sc1
    v_bitop3_b32 v163, v163, v142, v143 bitop3:0x96
    v_cvt_pk_bf16_f32 v150, v106, v122
    v_cvt_pk_bf16_f32 v151, v107, v123
    s_add_u32 s92, s96, 2097152
    v_permlane16_swap_b32 v146, v147
    buffer_store_dwordx2 v[146:147], v29, s[12:15], s92 offen offset:128 sc1
    v_bitop3_b32 v164, v164, v146, v147 bitop3:0x96
    ds_write_b32 v7, v35 offset:48
    v_cvt_pk_bf16_f32 v154, v108, v124
    v_cvt_pk_bf16_f32 v155, v109, v125
    s_add_u32 s92, s96, 2359296
    v_permlane16_swap_b32 v150, v151
    buffer_store_dwordx2 v[150:151], v29, s[12:15], s92 offen offset:128 sc1
    v_bitop3_b32 v165, v165, v150, v151 bitop3:0x96
    v_cvt_pk_bf16_f32 v158, v110, v126
    v_cvt_pk_bf16_f32 v159, v111, v127
    s_add_u32 s92, s96, 3145728
    v_permlane16_swap_b32 v154, v155
    buffer_store_dwordx2 v[154:155], v29, s[12:15], s92 offen offset:128 sc1
    v_bitop3_b32 v166, v166, v154, v155 bitop3:0x96
    s_add_u32 s92, s96, 3407872
    v_permlane16_swap_b32 v158, v159
    buffer_store_dwordx2 v[158:159], v29, s[12:15], s92 offen offset:128 sc1
    v_bitop3_b32 v167, v167, v158, v159 bitop3:0x96
    s_waitcnt lgkmcnt(0)
    v_cmp_ne_u32 vcc, 1, v34
    v_xor_b32_dpp v160, v160, v160 row_ror:8 row_mask:0xf bank_mask:0x3
    v_xor_b32_dpp v162, v162, v162 row_ror:8 row_mask:0xf bank_mask:0x3
    v_xor_b32_dpp v164, v164, v164 row_ror:8 row_mask:0xf bank_mask:0x3
    v_xor_b32_dpp v166, v166, v166 row_ror:8 row_mask:0xf bank_mask:0x3
    s_nop 0
    s_cbranch_vccnz L_lslow
L_lok:
    v_xor_b32_dpp v160, v161, v161 row_ror:8 row_mask:0xf bank_mask:0xc
    v_xor_b32_dpp v162, v163, v163 row_ror:8 row_mask:0xf bank_mask:0xc
    v_xor_b32_dpp v164, v165, v165 row_ror:8 row_mask:0xf bank_mask:0xc
    v_xor_b32_dpp v166, v167, v167 row_ror:8 row_mask:0xf bank_mask:0xc
    v_add_f32 v172, v172, v173
    v_xor_b32_dpp v160, v160, v160 row_half_mirror row_mask:0xf bank_mask:0x5
    v_xor_b32_dpp v164, v164, v164 row_half_mirror row_mask:0xf bank_mask:0x5
    v_add_f32 v174, v174, v175
    v_xor_b32_dpp v160, v162, v162 row_half_mirror row_mask:0xf bank_mask:0xa
    v_xor_b32_dpp v164, v166, v166 row_half_mirror row_mask:0xf bank_mask:0xa
    v_add_f32 v169, v172, v174
    v_xor_b32_dpp v160, v160, v160 quad_perm:[1,0,3,2] row_mask:0xf bank_mask:0xf
    v_xor_b32_dpp v164, v164, v164 quad_perm:[1,0,3,2] row_mask:0xf bank_mask:0xf
    v_bitop3_b32 v171, v168, v169, s56 bitop3:0x96
    v_xor_b32_dpp v170, v160, v160 quad_perm:[2,3,0,1] row_mask:0xf bank_mask:0xf
    v_xor_b32_dpp v164, v164, v164 quad_perm:[2,3,0,1] row_mask:0xf bank_mask:0xf
    s_mov_b32 exec_lo, 0x22222222
    s_mov_b32 exec_hi, 0x22222222
    v_mov_b32 v170, v164
    s_mov_b32 exec_lo, 0x33333333
    s_mov_b32 exec_hi, 0x33333333
    v_xor_b32 v171, v171, v170
    buffer_store_dwordx4 v[168:171], v30, s[12:15], s97 offen sc1
    s_endpgm
L_lslow:
    ds_read_b32 v34, v10 offset:64
    ds_read_b128 v[172:175], v32
    ds_read_b32 v168, v31
    s_waitcnt lgkmcnt(0)
    v_cmp_ne_u32 vcc, 1, v34
    s_nop 3
    s_cbranch_vccz L_lok
    s_sub_u32 s60, s60, 1
    s_cbranch_scc0 L_lslow
    s_branch L_lok
L_ps0:
    v_cmp_ne_u32 vcc, 3, v34
    s_nop 3
    s_cbranch_vccz L_pr0
    s_sleep 1
    s_sub_u32 s60, s60, 1
    s_cbranch_scc0 L_pp0
    s_branch L_pg0
L_pr0:
    s_branch L_pg0
L_ps1:
    v_cmp_ne_u32 vcc, 3, v34
    s_nop 3
    s_cbranch_vccz L_pr1
    s_sleep 1
    s_sub_u32 s60, s60, 1
    s_cbranch_scc0 L_pp1
    s_branch L_pg1
L_pr1:
    ds_read_b128 v[44:47], v33 offset:128
    ds_read_b128 v[48:51], v33 offset:160
    ds_read_b128 v[52:55], v33 offset:192
    ds_read_b128 v[56:59], v33 offset:224
    s_waitcnt lgkmcnt(0)
    s_nop 7
    v_mul_f32 v64, v64, v44
    v_mul_f32 v65, v65, v45
    v_mul_f32 v66, v66, v46
    v_mul_f32 v67, v67, v47
    v_mul_f32 v68, v68, v48
    v_mul_f32 v69, v69, v49
    v_mul_f32 v70, v70, v50
    v_mul_f32 v71, v71, v51
    v_mul_f32 v72, v72, v52
    v_mul_f32 v73, v73, v53
    v_mul_f32 v74, v74, v54
    v_mul_f32 v75, v75, v55
    v_mul_f32 v76, v76, v56
    v_mul_f32 v77, v77, v57
    v_mul_f32 v78, v78, v58
    v_mul_f32 v79, v79, v59
    v_mul_f32 v80, v80, v44
    v_mul_f32 v81, v81, v45
    v_mul_f32 v82, v82, v46
    v_mul_f32 v83, v83, v47
    v_mul_f32 v84, v84, v48
    v_mul_f32 v85, v85, v49
    v_mul_f32 v86, v86, v50
    v_mul_f32 v87, v87, v51
    v_mul_f32 v88, v88, v52
    v_mul_f32 v89, v89, v53
    v_mul_f32 v90, v90, v54
    v_mul_f32 v91, v91, v55
    v_mul_f32 v92, v92, v56
    v_mul_f32 v93, v93, v57
    v_mul_f32 v94, v94, v58
    v_mul_f32 v95, v95, v59
    v_mul_f32 v96, v96, v44
    v_mul_f32 v97, v97, v45
    v_mul_f32 v98, v98, v46
    v_mul_f32 v99, v99, v47
    v_mul_f32 v100, v100, v48
    v_mul_f32 v101, v101, v49
    v_mul_f32 v102, v102, v50
    v_mul_f32 v103, v103, v51
    v_mul_f32 v104, v104, v52
    v_mul_f32 v105, v105, v53
    v_mul_f32 v106, v106, v54
    v_mul_f32 v107, v107, v55
    v_mul_f32 v108, v108, v56
    v_mul_f32 v109, v109, v57
    v_mul_f32 v110, v110, v58
    v_mul_f32 v111, v111, v59
    v_mul_f32 v112, v112, v44
    v_mul_f32 v113, v113, v45
    v_mul_f32 v114, v114, v46
    v_mul_f32 v115, v115, v47
    v_mul_f32 v116, v116, v48
    v_mul_f32 v117, v117, v49
    v_mul_f32 v118, v118, v50
    v_mul_f32 v119, v119, v51
    v_mul_f32 v120, v120, v52
    v_mul_f32 v121, v121, v53
    v_mul_f32 v122, v122, v54
    v_mul_f32 v123, v123, v55
    v_mul_f32 v124, v124, v56
    v_mul_f32 v125, v125, v57
    v_mul_f32 v126, v126, v58
    v_mul_f32 v127, v127, v59
    s_nop 0
    s_branch L_pg1
L_ps2:
    v_cmp_ne_u32 vcc, 3, v34
    s_nop 3
    s_cbranch_vccz L_pr2
    s_sleep 1
    s_sub_u32 s60, s60, 1
    s_cbranch_scc0 L_pp2
    s_branch L_pg2
L_pr2:
    ds_read_b128 v[44:47], v33 offset:256
    ds_read_b128 v[48:51], v33 offset:288
    ds_read_b128 v[52:55], v33 offset:320
    ds_read_b128 v[56:59], v33 offset:352
    s_waitcnt lgkmcnt(0)
    s_nop 7
    v_mul_f32 v64, v64, v44
    v_mul_f32 v65, v65, v45
    v_mul_f32 v66, v66, v46
    v_mul_f32 v67, v67, v47
    v_mul_f32 v68, v68, v48
    v_mul_f32 v69, v69, v49
    v_mul_f32 v70, v70, v50
    v_mul_f32 v71, v71, v51
    v_mul_f32 v72, v72, v52
    v_mul_f32 v73, v73, v53
    v_mul_f32 v74, v74, v54
    v_mul_f32 v75, v75, v55
    v_mul_f32 v76, v76, v56
    v_mul_f32 v77, v77, v57
    v_mul_f32 v78, v78, v58
    v_mul_f32 v79, v79, v59
    v_mul_f32 v80, v80, v44
    v_mul_f32 v81, v81, v45
    v_mul_f32 v82, v82, v46
    v_mul_f32 v83, v83, v47
    v_mul_f32 v84, v84, v48
    v_mul_f32 v85, v85, v49
    v_mul_f32 v86, v86, v50
    v_mul_f32 v87, v87, v51
    v_mul_f32 v88, v88, v52
    v_mul_f32 v89, v89, v53
    v_mul_f32 v90, v90, v54
    v_mul_f32 v91, v91, v55
    v_mul_f32 v92, v92, v56
    v_mul_f32 v93, v93, v57
    v_mul_f32 v94, v94, v58
    v_mul_f32 v95, v95, v59
    v_mul_f32 v96, v96, v44
    v_mul_f32 v97, v97, v45
    v_mul_f32 v98, v98, v46
    v_mul_f32 v99, v99, v47
    v_mul_f32 v100, v100, v48
    v_mul_f32 v101, v101, v49
    v_mul_f32 v102, v102, v50
    v_mul_f32 v103, v103, v51
    v_mul_f32 v104, v104, v52
    v_mul_f32 v105, v105, v53
    v_mul_f32 v106, v106, v54
    v_mul_f32 v107, v107, v55
    v_mul_f32 v108, v108, v56
    v_mul_f32 v109, v109, v57
    v_mul_f32 v110, v110, v58
    v_mul_f32 v111, v111, v59
    v_mul_f32 v112, v112, v44
    v_mul_f32 v113, v113, v45
    v_mul_f32 v114, v114, v46
    v_mul_f32 v115, v115, v47
    v_mul_f32 v116, v116, v48
    v_mul_f32 v117, v117, v49
    v_mul_f32 v118, v118, v50
    v_mul_f32 v119, v119, v51
    v_mul_f32 v120, v120, v52
    v_mul_f32 v121, v121, v53
    v_mul_f32 v122, v122, v54
    v_mul_f32 v123, v123, v55
    v_mul_f32 v124, v124, v56
    v_mul_f32 v125, v125, v57
    v_mul_f32 v126, v126, v58
    v_mul_f32 v127, v127, v59
    s_nop 0
    s_branch L_pg2
L_ps3:
    v_cmp_ne_u32 vcc, 3, v34
    s_nop 3
    s_cbranch_vccz L_pr3
    s_sleep 1
    s_sub_u32 s60, s60, 1
    s_cbranch_scc0 L_pp3
    s_branch L_pg3
L_pr3:
    ds_read_b128 v[44:47], v33 offset:384
    ds_read_b128 v[48:51], v33 offset:416
    ds_read_b128 v[52:55], v33 offset:448
    ds_read_b128 v[56:59], v33 offset:480
    s_waitcnt lgkmcnt(0)
    s_nop 7
    v_mul_f32 v64, v64, v44
    v_mul_f32 v65, v65, v45
    v_mul_f32 v66, v66, v46
    v_mul_f32 v67, v67, v47
    v_mul_f32 v68, v68, v48
    v_mul_f32 v69, v69, v49
    v_mul_f32 v70, v70, v50
    v_mul_f32 v71, v71, v51
    v_mul_f32 v72, v72, v52
    v_mul_f32 v73, v73, v53
    v_mul_f32 v74, v74, v54
    v_mul_f32 v75, v75, v55
    v_mul_f32 v76, v76, v56
    v_mul_f32 v77, v77, v57
    v_mul_f32 v78, v78, v58
    v_mul_f32 v79, v79, v59
    v_mul_f32 v80, v80, v44
    v_mul_f32 v81, v81, v45
    v_mul_f32 v82, v82, v46
    v_mul_f32 v83, v83, v47
    v_mul_f32 v84, v84, v48
    v_mul_f32 v85, v85, v49
    v_mul_f32 v86, v86, v50
    v_mul_f32 v87, v87, v51
    v_mul_f32 v88, v88, v52
    v_mul_f32 v89, v89, v53
    v_mul_f32 v90, v90, v54
    v_mul_f32 v91, v91, v55
    v_mul_f32 v92, v92, v56
    v_mul_f32 v93, v93, v57
    v_mul_f32 v94, v94, v58
    v_mul_f32 v95, v95, v59
    v_mul_f32 v96, v96, v44
    v_mul_f32 v97, v97, v45
    v_mul_f32 v98, v98, v46
    v_mul_f32 v99, v99, v47
    v_mul_f32 v100, v100, v48
    v_mul_f32 v101, v101, v49
    v_mul_f32 v102, v102, v50
    v_mul_f32 v103, v103, v51
    v_mul_f32 v104, v104, v52
    v_mul_f32 v105, v105, v53
    v_mul_f32 v106, v106, v54
    v_mul_f32 v107, v107, v55
    v_mul_f32 v108, v108, v56
    v_mul_f32 v109, v109, v57
    v_mul_f32 v110, v110, v58
    v_mul_f32 v111, v111, v59
    v_mul_f32 v112, v112, v44
    v_mul_f32 v113, v113, v45
    v_mul_f32 v114, v114, v46
    v_mul_f32 v115, v115, v47
    v_mul_f32 v116, v116, v48
    v_mul_f32 v117, v117, v49
    v_mul_f32 v118, v118, v50
    v_mul_f32 v119, v119, v51
    v_mul_f32 v120, v120, v52
    v_mul_f32 v121, v121, v53
    v_mul_f32 v122, v122, v54
    v_mul_f32 v123, v123, v55
    v_mul_f32 v124, v124, v56
    v_mul_f32 v125, v125, v57
    v_mul_f32 v126, v126, v58
    v_mul_f32 v127, v127, v59
    s_nop 0
    s_branch L_pg3
L_comp:
    v_lshlrev_b32 v16, 2, v1
    v_add_u32 v16, 162816, v16
    v_mov_b32 v17, 0
    ds_write_b32 v16, v17
    s_waitcnt lgkmcnt(0)
    s_barrier
    s_load_dword s56, s[12:13], 192512
    s_mov_b64 s[16:17], s[66:67]
    s_mov_b32 s57, 0x3f803f80
    s_mov_b32 s58, 0x3f80
    s_mov_b32 s59, 0x3f800000
    s_mov_b32 s62, 0xffff0000
    s_add_u32 s63, s90, 80896
    s_xor_b32 s63, s63, 524288
    s_add_u32 s99, s90, 196608
    s_add_u32 s99, s99, 4096
    s_xor_b32 s99, s99, 1048576
    s_add_u32 m0, s91, 4096
    v_xor_b32 v104, 0, v2
    v_xor_b32 v105, 32, v2
    v_xor_b32 v106, 64, v2
    v_xor_b32 v107, 96, v2
    v_xor_b32 v108, 128, v2
    v_xor_b32 v109, 160, v2
    v_xor_b32 v110, 192, v2
    v_xor_b32 v111, 224, v2
    v_xor_b32 v21, 0xe0, v2
    buffer_load_dwordx4 v[24:27], v21, s[16:19], s63 offen nt
    v_mov_b32 v20, 128
    global_load_dword v100, v20, s[86:87] sc1
    s_add_u32 s6, s91, 31744
    v_add_u32 v28, s6, v2
    s_lshl_b32 s90, s4, 15
    s_lshl_b32 s95, s3, 13
    s_add_u32 s90, s90, s95
    s_add_u32 s92, s90, 4096
    s_lshl_b32 s93, s3, 12
    s_lshl_b32 s94, s4, 5
    s_add_u32 s93, s93, s94
    s_add_u32 s93, s93, 131072
    v_lshrrev_b32 v16, 1, v1
    v_lshlrev_b32 v16, 7, v16
    s_and_b32 s94, s3, 1
    s_lshl_b32 s94, s94, 7
    v_xor_b32 v17, s94, v2
    s_add_u32 s95, s95, 130048
    v_add_u32 v17, s95, v17
    v_xor_b32 v96, 0, v17
    v_xor_b32 v97, 32, v17
    v_xor_b32 v98, 64, v17
    v_xor_b32 v99, 96, v17
    v_lshrrev_b32 v22, 5, v1
    v_and_b32 v29, 1, v3
    v_lshlrev_b32 v23, 4, v29
    v_lshl_add_u32 v23, v22, 9, v23
    v_bfe_u32 v18, v1, 3, 1
    v_lshl_add_u32 v18, v18, 2, v4
    v_lshl_add_u32 v18, v18, 5, v23
    v_lshl_add_u32 v18, v11, 10, v18
    v_add_u32 v18, 130048, v18
    v_bfe_u32 v20, v1, 2, 2
    v_lshl_add_u32 v21, v4, 2, v20
    v_lshl_add_u32 v19, v21, 10, v23
    v_and_b32 v21, 14, v21
    v_lshl_add_u32 v19, v21, 4, v19
    v_add_u32 v19, s91, v19
    v_xor_b32 v48, 0, v19
    v_xor_b32 v56, 0, v18
    v_xor_b32 v49, 32, v19
    v_xor_b32 v57, 32, v18
    v_xor_b32 v50, 64, v19
    v_xor_b32 v58, 64, v18
    v_xor_b32 v51, 96, v19
    v_xor_b32 v59, 96, v18
    v_xor_b32 v52, 128, v19
    v_xor_b32 v60, 128, v18
    v_xor_b32 v53, 160, v19
    v_xor_b32 v61, 160, v18
    v_xor_b32 v54, 192, v19
    v_xor_b32 v62, 192, v18
    v_xor_b32 v55, 224, v19
    v_xor_b32 v63, 224, v18
    v_and_b32 v20, 31, v1
    s_lshl_b32 s95, s3, 2
    s_add_u32 s95, s95, 163328
    v_lshl_add_u32 v6, v20, 4, s95
    v_lshlrev_b32 v8, 9, v22
    v_lshl_add_u32 v8, v11, 4, v8
    v_lshl_add_u32 v8, v29, 3, v8
    s_lshl_b32 s95, s3, 10
    s_add_u32 s95, s95, 131072
    v_add_u32 v8, s95, v8
    v_lshlrev_b32 v9, 4, v11
    v_add_u32 v9, 163328, v9
    v_lshlrev_b32 v11, 2, v11
    v_add_u32 v11, 147456, v11
    v_mov_b32 v14, 0
    v_mov_b32 v15, 0
    v_mov_b32 v0, 1
    v_mov_b32 v5, 2
    s_mov_b32 s98, 0x42700000
    s_mov_b32 s96, 1
    s_and_b32 s94, s2, 63
    s_lshl_b32 s94, s94, 7
    s_add_u32 s94, s94, 147456
    s_add_u32 s0, s12, s94
    s_addc_u32 s1, s13, 0
    s_waitcnt lgkmcnt(0)
    s_add_u32 s56, s56, 0x9e3779b9
    s_cmp_eq_u32 s3, 0
    s_cbranch_scc1 L_hu0
    v_mov_b32 v20, 162816
    s_mov_b32 s60, 8000000
lw_57:
    ds_read_b32 v19, v20 offset:80
    s_waitcnt lgkmcnt(0)
    v_cmp_gt_u32 vcc, 1, v19
    s_nop 3
    s_cbranch_vccz lwd_58
    s_sub_u32 s60, s60, 1
    s_cbranch_scc0 lw_57
lwd_58:
    s_branch L_hugo2
L_hu0:
    s_mov_b32 s60, 200000
L_hu:
    s_load_dword s94, s[0:1], 0 glc
    s_waitcnt lgkmcnt(0)
    s_cmp_eq_u32 s94, s56
    s_cbranch_scc1 L_hugo
    s_sub_u32 s60, s60, 1
    s_cbranch_scc0 L_hu
L_hugo:
    ds_write_b32 v7, v0 offset:80
L_hugo2:
    s_mov_b32 s60, 200000
L_qload:
    buffer_load_dwordx2 v[30:31], v16, s[12:15], s93 offen sc1
    buffer_load_dwordx4 v[128:131], v2, s[12:15], s90 offen offset:0 sc1
    buffer_load_dwordx4 v[132:135], v2, s[12:15], s90 offen offset:1024 sc1
    buffer_load_dwordx4 v[136:139], v2, s[12:15], s90 offen offset:2048 sc1
    buffer_load_dwordx4 v[140:143], v2, s[12:15], s90 offen offset:3072 sc1
    buffer_load_dwordx4 v[144:147], v2, s[12:15], s92 offen offset:0 sc1
    buffer_load_dwordx4 v[148:151], v2, s[12:15], s92 offen offset:1024 sc1
    buffer_load_dwordx4 v[152:155], v2, s[12:15], s92 offen offset:2048 sc1
    buffer_load_dwordx4 v[156:159], v2, s[12:15], s92 offen offset:3072 sc1
    ds_write_b32 v7, v0 offset:80
    s_waitcnt vmcnt(8)
    v_bitop3_b32 v21, v30, v31, s56 bitop3:0x96
    s_waitcnt vmcnt(7)
    ds_write_b128 v96, v[128:131] offset:0
    v_bitop3_b32 v19, v128, v129, v130 bitop3:0x96
    v_xor_b32 v19, v131, v19
    s_waitcnt vmcnt(6)
    ds_write_b128 v97, v[132:135] offset:1024
    v_bitop3_b32 v19, v19, v132, v133 bitop3:0x96
    v_bitop3_b32 v19, v19, v134, v135 bitop3:0x96
    s_waitcnt vmcnt(5)
    ds_write_b128 v98, v[136:139] offset:2048
    v_bitop3_b32 v19, v19, v136, v137 bitop3:0x96
    v_bitop3_b32 v19, v19, v138, v139 bitop3:0x96
    s_waitcnt vmcnt(4)
    ds_write_b128 v99, v[140:143] offset:3072
    v_bitop3_b32 v19, v19, v140, v141 bitop3:0x96
    v_bitop3_b32 v19, v19, v142, v143 bitop3:0x96
    s_waitcnt vmcnt(3)
    ds_write_b128 v96, v[144:147] offset:4096
    v_bitop3_b32 v19, v19, v144, v145 bitop3:0x96
    v_bitop3_b32 v19, v19, v146, v147 bitop3:0x96
    s_waitcnt vmcnt(2)
    ds_write_b128 v97, v[148:151] offset:5120
    v_bitop3_b32 v19, v19, v148, v149 bitop3:0x96
    v_bitop3_b32 v19, v19, v150, v151 bitop3:0x96
    s_waitcnt vmcnt(1)
    ds_write_b128 v98, v[152:155] offset:6144
    v_bitop3_b32 v19, v19, v152, v153 bitop3:0x96
    v_bitop3_b32 v19, v19, v154, v155 bitop3:0x96
    s_waitcnt vmcnt(0)
    ds_write_b128 v99, v[156:159] offset:7168
    v_bitop3_b32 v19, v19, v156, v157 bitop3:0x96
    v_bitop3_b32 v19, v19, v158, v159 bitop3:0x96
    s_nop 1
    v_xor_b32_dpp v19, v19, v19 quad_perm:[1,0,3,2] row_mask:0xf bank_mask:0xf
    v_xor_b32 v19, v19, v30
    s_nop 1
    v_xor_b32_dpp v19, v19, v19 quad_perm:[2,3,0,1] row_mask:0xf bank_mask:0xf
    s_nop 1
    v_xor_b32_dpp v19, v19, v19 row_ror:4 row_mask:0xf bank_mask:0xf
    s_nop 1
    v_xor_b32_dpp v19, v19, v19 row_ror:8 row_mask:0xf bank_mask:0xf
    v_mov_b32 v20, v19
    s_nop 1
    v_permlane16_swap_b32 v19, v20
    v_xor_b32 v19, v19, v20
    v_mov_b32 v20, v19
    s_nop 1
    v_permlane32_swap_b32 v19, v20
    v_xor_b32 v19, v19, v20
    v_or_b32 v19, v19, v21
    v_cmp_ne_u32 vcc, 0, v19
    s_nop 3
    s_cbranch_vccz L_qdone
    s_sub_u32 s60, s60, 1
    s_cbranch_scc0 L_qload
L_qdone:
    ds_write_b32 v7, v0 offset:16
    s_mov_b32 s60, 8000000
lw_59:
    ds_read_b32 v19, v7 offset:0
    s_waitcnt lgkmcnt(0)
    v_cmp_gt_u32 vcc, 1, v19
    s_nop 3
    s_cbranch_vccz lwd_60
    s_sleep 1
    s_sub_u32 s60, s60, 1
    s_cbranch_scc0 lw_59
lwd_60:
    s_mov_b32 s60, 8000000
lw_61:
    ds_read_b32 v19, v10 offset:16
    s_waitcnt lgkmcnt(0)
    v_cmp_gt_u32 vcc, 1, v19
    s_nop 3
    s_cbranch_vccz lwd_62
    s_sub_u32 s60, s60, 1
    s_cbranch_scc0 lw_61
lwd_62:
    ds_read_b128 v[128:131], v56 offset:0
    ds_read_b128 v[192:195], v56 offset:16384
    ds_read_b128 v[64:67], v48 offset:0
    ds_read_b128 v[132:135], v56 offset:256
    ds_read_b128 v[196:199], v56 offset:16640
    ds_read_b128 v[68:71], v48 offset:256
    ds_read_b128 v[136:139], v57 offset:0
    ds_read_b128 v[200:203], v57 offset:16384
    ds_read_b128 v[72:75], v49 offset:0
    ds_read_b128 v[140:143], v57 offset:256
    ds_read_b128 v[204:207], v57 offset:16640
    ds_read_b128 v[76:79], v49 offset:256
    s_waitcnt lgkmcnt(9)
    v_mfma_f32_16x16x32_bf16 v[32:35], v[64:67], v[128:131], 0
    v_mfma_f32_16x16x32_bf16 v[36:39], v[64:67], v[192:195], 0
    ds_read_b128 v[144:147], v58 offset:0
    ds_read_b128 v[208:211], v58 offset:16384
    ds_read_b128 v[80:83], v50 offset:0
    s_waitcnt lgkmcnt(9)
    v_mfma_f32_16x16x32_bf16 v[32:35], v[68:71], v[132:135], v[32:35]
    v_mfma_f32_16x16x32_bf16 v[36:39], v[68:71], v[196:199], v[36:39]
    ds_read_b128 v[148:151], v58 offset:256
    ds_read_b128 v[212:215], v58 offset:16640
    ds_read_b128 v[84:87], v50 offset:256
    s_waitcnt lgkmcnt(9)
    v_mfma_f32_16x16x32_bf16 v[32:35], v[72:75], v[136:139], v[32:35]
    v_mfma_f32_16x16x32_bf16 v[36:39], v[72:75], v[200:203], v[36:39]
    ds_read_b128 v[152:155], v59 offset:0
    ds_read_b128 v[216:219], v59 offset:16384
    ds_read_b128 v[88:91], v51 offset:0
    s_waitcnt lgkmcnt(9)
    v_mfma_f32_16x16x32_bf16 v[32:35], v[76:79], v[140:143], v[32:35]
    v_mfma_f32_16x16x32_bf16 v[36:39], v[76:79], v[204:207], v[36:39]
    ds_read_b128 v[156:159], v59 offset:256
    ds_read_b128 v[220:223], v59 offset:16640
    ds_read_b128 v[92:95], v51 offset:256
    s_waitcnt lgkmcnt(9)
    v_mfma_f32_16x16x32_bf16 v[32:35], v[80:83], v[144:147], v[32:35]
    v_mfma_f32_16x16x32_bf16 v[36:39], v[80:83], v[208:211], v[36:39]
    ds_read_b128 v[160:163], v60 offset:0
    ds_read_b128 v[224:227], v60 offset:16384
    ds_read_b128 v[64:67], v52 offset:0
    s_waitcnt lgkmcnt(9)
    v_mfma_f32_16x16x32_bf16 v[32:35], v[84:87], v[148:151], v[32:35]
    v_mfma_f32_16x16x32_bf16 v[36:39], v[84:87], v[212:215], v[36:39]
    ds_read_b128 v[164:167], v60 offset:256
    ds_read_b128 v[228:231], v60 offset:16640
    ds_read_b128 v[68:71], v52 offset:256
    s_waitcnt lgkmcnt(9)
    v_mfma_f32_16x16x32_bf16 v[32:35], v[88:91], v[152:155], v[32:35]
    v_mfma_f32_16x16x32_bf16 v[36:39], v[88:91], v[216:219], v[36:39]
    ds_read_b128 v[168:171], v61 offset:0
    ds_read_b128 v[232:235], v61 offset:16384
    ds_read_b128 v[72:75], v53 offset:0
    s_waitcnt lgkmcnt(9)
    v_mfma_f32_16x16x32_bf16 v[32:35], v[92:95], v[156:159], v[32:35]
    v_mfma_f32_16x16x32_bf16 v[36:39], v[92:95], v[220:223], v[36:39]
    ds_read_b128 v[172:175], v61 offset:256
    ds_read_b128 v[236:239], v61 offset:16640
    ds_read_b128 v[76:79], v53 offset:256
    s_waitcnt lgkmcnt(9)
    v_mfma_f32_16x16x32_bf16 v[32:35], v[64:67], v[160:163], v[32:35]
    v_mfma_f32_16x16x32_bf16 v[36:39], v[64:67], v[224:227], v[36:39]
    ds_read_b128 v[176:179], v62 offset:0
    ds_read_b128 v[240:243], v62 offset:16384
    ds_read_b128 v[80:83], v54 offset:0
    s_waitcnt lgkmcnt(9)
    v_mfma_f32_16x16x32_bf16 v[32:35], v[68:71], v[164:167], v[32:35]
    v_mfma_f32_16x16x32_bf16 v[36:39], v[68:71], v[228:231], v[36:39]
    ds_read_b128 v[180:183], v62 offset:256
    ds_read_b128 v[244:247], v62 offset:16640
    ds_read_b128 v[84:87], v54 offset:256
    s_waitcnt lgkmcnt(9)
    v_mfma_f32_16x16x32_bf16 v[32:35], v[72:75], v[168:171], v[32:35]
    v_mfma_f32_16x16x32_bf16 v[36:39], v[72:75], v[232:235], v[36:39]
    ds_read_b128 v[184:187], v63 offset:0
    ds_read_b128 v[248:251], v63 offset:16384
    ds_read_b128 v[88:91], v55 offset:0
    s_waitcnt lgkmcnt(9)
    v_mfma_f32_16x16x32_bf16 v[32:35], v[76:79], v[172:175], v[32:35]
    v_mfma_f32_16x16x32_bf16 v[36:39], v[76:79], v[236:239], v[36:39]
    ds_read_b128 v[188:191], v63 offset:256
    ds_read_b128 v[252:255], v63 offset:16640
    ds_read_b128 v[92:95], v55 offset:256
    s_waitcnt lgkmcnt(9)
    v_mfma_f32_16x16x32_bf16 v[32:35], v[80:83], v[176:179], v[32:35]
    v_mfma_f32_16x16x32_bf16 v[36:39], v[80:83], v[240:243], v[36:39]
    s_waitcnt lgkmcnt(6)
    v_mfma_f32_16x16x32_bf16 v[32:35], v[84:87], v[180:183], v[32:35]
    v_mfma_f32_16x16x32_bf16 v[36:39], v[84:87], v[244:247], v[36:39]
    s_waitcnt lgkmcnt(3)
    v_mfma_f32_16x16x32_bf16 v[32:35], v[88:91], v[184:187], v[32:35]
    v_mfma_f32_16x16x32_bf16 v[36:39], v[88:91], v[248:251], v[36:39]
    s_waitcnt lgkmcnt(0)
    v_mfma_f32_16x16x32_bf16 v[32:35], v[92:95], v[188:191], v[32:35]
    v_mfma_f32_16x16x32_bf16 v[36:39], v[92:95], v[252:255], v[36:39]
    v_mov_b32 v18, s96
    s_nop 5
    v_max3_f32 v16, v32, v33, v34
    v_max_f32 v16, v16, v35
    v_max3_f32 v17, v36, v37, v38
    v_max_f32 v17, v17, v39
    s_nop 1
    v_permlane16_swap_b32 v16, v17
    v_max_f32 v16, v16, v17
    v_mov_b32 v17, v16
    s_nop 1
    v_permlane32_swap_b32 v16, v17
    v_max_f32 v16, v16, v17
    ds_write_b32 v6, v16
    ds_write_b32 v7, v18 offset:32
    s_mov_b32 s60, 8000000
L_m0:
    ds_read_b32 v18, v10 offset:32
    ds_read_b128 v[64:67], v9
    ds_read_b128 v[68:71], v9 offset:256
    s_waitcnt lgkmcnt(0)
    v_cmp_gt_u32 vcc, s96, v18
    s_nop 3
    s_cbranch_vccz L_m0go
    s_sub_u32 s60, s60, 1
    s_cbranch_scc0 L_m0
L_m0go:
    v_max3_f32 v16, v64, v65, v66
    v_max_f32 v16, v16, v67
    v_sub_f32 v32, v32, v16
    v_sub_f32 v33, v33, v16
    v_sub_f32 v34, v34, v16
    v_sub_f32 v35, v35, v16
    v_max3_f32 v17, v68, v69, v70
    v_max_f32 v17, v17, v71
    v_sub_f32 v36, v36, v17
    v_sub_f32 v37, v37, v17
    v_sub_f32 v38, v38, v17
    v_sub_f32 v39, v39, v17
    v_exp_f32 v44, v32
    v_exp_f32 v45, v33
    v_exp_f32 v46, v34
    v_exp_f32 v47, v35
    v_cvt_pk_bf16_f32 v40, v44, v45
    v_cvt_pk_bf16_f32 v41, v46, v47
    ds_write_b64 v8, v[40:41] offset:0
    v_exp_f32 v44, v36
    v_exp_f32 v45, v37
    v_exp_f32 v46, v38
    v_exp_f32 v47, v39
    v_cvt_pk_bf16_f32 v42, v44, v45
    v_cvt_pk_bf16_f32 v43, v46, v47
    ds_write_b64 v8, v[42:43] offset:256
    ds_write_b32 v7, v5 offset:96
    ds_write_b128 v28, v[24:27]
    ds_write2_b32 v11, v16, v17 offset0:128 offset1:144
    v_sub_f32 v12, 0, v16
    v_sub_f32 v13, 0, v17
    v_dot2_f32_bf16 v14, v40, s57, v14
    v_dot2_f32_bf16 v15, v42, s57, v15
    v_dot2_f32_bf16 v14, v41, s57, v14
    v_dot2_f32_bf16 v15, v43, s57, v15
    s_cmp_lg_u32 s3, 1
    s_nop 0
    s_cbranch_scc1 L_nom0
    v_permlane16_swap_b32 v16, v17
    s_lshl_b32 s94, s4, 12
    s_lshl_b32 s95, s5, 7
    s_add_u32 s94, s94, s95
    s_add_u32 s94, s94, 229376
    v_lshlrev_b32 v18, 2, v1
    v_xor_b32 v16, s56, v16
    s_mov_b32 exec_lo, 0xffffffff
    s_mov_b32 exec_hi, 0x0
    buffer_store_dword v16, v18, s[12:15], s94 offen sc1
    s_mov_b64 exec, -1
L_nom0:
    s_mov_b32 s60, 8000000
    v_mov_b32 v32, v12
    v_mov_b32 v33, v12
    v_mov_b32 v34, v12
    v_mov_b32 v35, v12
    v_mov_b32 v36, v13
    v_mov_b32 v37, v13
    v_mov_b32 v38, v13
    v_mov_b32 v39, v13
L_l1:
    ds_read_b32 v18, v7 offset:0
    s_waitcnt lgkmcnt(0)
    v_cmp_ge_u32 vcc, 1, v18
    s_nop 3
    s_cbranch_vccz L_l1go
    s_sleep 1
    s_sub_u32 s60, s60, 1
    s_cbranch_scc0 L_l1
L_l1go:
    ds_read_b128 v[64:67], v48 offset:16384
    ds_read_b128 v[68:71], v48 offset:16640
    ds_read_b128 v[72:75], v49 offset:16384
    ds_read_b128 v[76:79], v49 offset:16640
    ds_read_b128 v[80:83], v50 offset:16384
    ds_read_b128 v[84:87], v50 offset:16640
    s_waitcnt lgkmcnt(5)
    v_mfma_f32_16x16x32_bf16 v[32:35], v[64:67], v[128:131], v[32:35]
    v_mfma_f32_16x16x32_bf16 v[36:39], v[64:67], v[192:195], v[36:39]
    ds_read_b128 v[88:91], v51 offset:16384
    s_waitcnt lgkmcnt(5)
    v_mfma_f32_16x16x32_bf16 v[32:35], v[68:71], v[132:135], v[32:35]
    v_mfma_f32_16x16x32_bf16 v[36:39], v[68:71], v[196:199], v[36:39]
    ds_read_b128 v[92:95], v51 offset:16640
    s_waitcnt lgkmcnt(5)
    v_mfma_f32_16x16x32_bf16 v[32:35], v[72:75], v[136:139], v[32:35]
    v_mfma_f32_16x16x32_bf16 v[36:39], v[72:75], v[200:203], v[36:39]
    ds_read_b128 v[64:67], v52 offset:16384
    s_waitcnt lgkmcnt(5)
    v_mfma_f32_16x16x32_bf16 v[32:35], v[76:79], v[140:143], v[32:35]
    v_mfma_f32_16x16x32_bf16 v[36:39], v[76:79], v[204:207], v[36:39]
    ds_read_b128 v[68:71], v52 offset:16640
    s_waitcnt lgkmcnt(5)
    v_mfma_f32_16x16x32_bf16 v[32:35], v[80:83], v[144:147], v[32:35]
    v_mfma_f32_16x16x32_bf16 v[36:39], v[80:83], v[208:211], v[36:39]
    ds_read_b128 v[72:75], v53 offset:16384
    s_waitcnt lgkmcnt(5)
    v_mfma_f32_16x16x32_bf16 v[32:35], v[84:87], v[148:151], v[32:35]
    v_mfma_f32_16x16x32_bf16 v[36:39], v[84:87], v[212:215], v[36:39]
    ds_read_b128 v[76:79], v53 offset:16640
    s_waitcnt lgkmcnt(5)
    v_mfma_f32_16x16x32_bf16 v[32:35], v[88:91], v[152:155], v[32:35]
    v_mfma_f32_16x16x32_bf16 v[36:39], v[88:91], v[216:219], v[36:39]
    ds_read_b128 v[80:83], v54 offset:16384
    s_waitcnt lgkmcnt(5)
    v_mfma_f32_16x16x32_bf16 v[32:35], v[92:95], v[156:159], v[32:35]
    v_mfma_f32_16x16x32_bf16 v[36:39], v[92:95], v[220:223], v[36:39]
    ds_read_b128 v[84:87], v54 offset:16640
    s_waitcnt lgkmcnt(5)
    v_mfma_f32_16x16x32_bf16 v[32:35], v[64:67], v[160:163], v[32:35]
    v_mfma_f32_16x16x32_bf16 v[36:39], v[64:67], v[224:227], v[36:39]
    ds_read_b128 v[88:91], v55 offset:16384
    s_waitcnt lgkmcnt(5)
    v_mfma_f32_16x16x32_bf16 v[32:35], v[68:71], v[164:167], v[32:35]
    v_mfma_f32_16x16x32_bf16 v[36:39], v[68:71], v[228:231], v[36:39]
    ds_read_b128 v[92:95], v55 offset:16640
    s_waitcnt lgkmcnt(5)
    v_mfma_f32_16x16x32_bf16 v[32:35], v[72:75], v[168:171], v[32:35]
    v_mfma_f32_16x16x32_bf16 v[36:39], v[72:75], v[232:235], v[36:39]
    s_waitcnt lgkmcnt(4)
    v_mfma_f32_16x16x32_bf16 v[32:35], v[76:79], v[172:175], v[32:35]
    v_mfma_f32_16x16x32_bf16 v[36:39], v[76:79], v[236:239], v[36:39]
    s_waitcnt lgkmcnt(3)
    v_mfma_f32_16x16x32_bf16 v[32:35], v[80:83], v[176:179], v[32:35]
    v_mfma_f32_16x16x32_bf16 v[36:39], v[80:83], v[240:243], v[36:39]
    s_waitcnt lgkmcnt(2)
    v_mfma_f32_16x16x32_bf16 v[32:35], v[84:87], v[180:183], v[32:35]
    v_mfma_f32_16x16x32_bf16 v[36:39], v[84:87], v[244:247], v[36:39]
    s_waitcnt lgkmcnt(1)
    v_mfma_f32_16x16x32_bf16 v[32:35], v[88:91], v[184:187], v[32:35]
    v_mfma_f32_16x16x32_bf16 v[36:39], v[88:91], v[248:251], v[36:39]
    s_waitcnt lgkmcnt(0)
    v_mfma_f32_16x16x32_bf16 v[32:35], v[92:95], v[188:191], v[32:35]
    v_mfma_f32_16x16x32_bf16 v[36:39], v[92:95], v[252:255], v[36:39]
    s_nop 6
    v_exp_f32 v44, v32
    v_exp_f32 v45, v33
    v_exp_f32 v46, v34
    v_exp_f32 v47, v35
    v_max3_f32 v19, v32, v33, v34
    v_max3_f32 v19, v35, v36, v19
    v_cvt_pk_bf16_f32 v40, v44, v45
    v_cvt_pk_bf16_f32 v41, v46, v47
    ds_write_b64 v8, v[40:41] offset:4096
    v_exp_f32 v44, v36
    v_exp_f32 v45, v37
    v_exp_f32 v46, v38
    v_exp_f32 v47, v39
    v_max3_f32 v19, v37, v38, v19
    v_max_f32 v19, v39, v19
    v_cmp_lt_f32 vcc, s98, v19
    v_cvt_pk_bf16_f32 v42, v44, v45
    v_cvt_pk_bf16_f32 v43, v46, v47
    ds_write_b64 v8, v[42:43] offset:4352
    s_cmp_eq_u64 vcc, 0
    s_cselect_b32 s91, 2, 1
    v_mov_b32 v18, s91
    ds_write_b32 v7, v18 offset:112
    s_mov_b32 s60, 8000000
L_c1:
    ds_read_b32 v18, v10 offset:112
    s_waitcnt lgkmcnt(0)
    v_cmp_ne_u32 vcc, 2, v18
    s_nop 3
    s_cbranch_vccnz L_cs1
L_cg1:
    v_dot2_f32_bf16 v14, v40, s57, v14
    v_dot2_f32_bf16 v15, v42, s57, v15
    v_dot2_f32_bf16 v14, v41, s57, v14
    v_dot2_f32_bf16 v15, v43, s57, v15
    s_mov_b32 s60, 8000000
    v_mov_b32 v32, v12
    v_mov_b32 v33, v12
    v_mov_b32 v34, v12
    v_mov_b32 v35, v12
    v_mov_b32 v36, v13
    v_mov_b32 v37, v13
    v_mov_b32 v38, v13
    v_mov_b32 v39, v13
    s_add_u32 s94, s3, 1
    s_mov_b32 s60, 8000000
lw_63:
    ds_read_b32 v18, v10 offset:48
    s_waitcnt lgkmcnt(0)
    v_cmp_gt_u32 vcc, s94, v18
    s_nop 3
    s_cbranch_vccz lwd_64
    s_sub_u32 s60, s60, 1
    s_cbranch_scc0 lw_63
lwd_64:
    s_cmp_lg_u32 s3, 0
    s_cbranch_scc1 nogo_65
    s_sub_u32 s92, s2, 128
    s_lshl_b32 s92, s92, 7
    s_add_u32 s92, s92, 163840
    v_mov_b32 v18, s56
    v_lshlrev_b32 v19, 2, v1
    s_mov_b32 exec_lo, 0xffffffff
    s_mov_b32 exec_hi, 0x0
    buffer_store_dword v18, v19, s[12:15], s92 offen sc1
    s_mov_b64 exec, -1
nogo_65:
    buffer_load_dwordx4 v106, s[16:19], s99 offen offset:0 nt lds
    buffer_load_dwordx4 v106, s[16:19], s99 offen offset:1024 nt lds
    buffer_load_dwordx4 v107, s[16:19], s99 offen offset:2048 nt lds
    buffer_load_dwordx4 v107, s[16:19], s99 offen offset:3072 nt lds
    s_add_u32 s99, s99, 4096
    s_xor_b32 s99, s99, 524288
    s_add_u32 m0, m0, 4096
    s_nop 0
    buffer_load_dwordx4 v108, s[16:19], s99 offen offset:0 nt lds
    buffer_load_dwordx4 v108, s[16:19], s99 offen offset:1024 nt lds
    buffer_load_dwordx4 v109, s[16:19], s99 offen offset:2048 nt lds
    buffer_load_dwordx4 v109, s[16:19], s99 offen offset:3072 nt lds
    s_add_u32 s99, s99, 4096
    s_xor_b32 s99, s99, 1048576
    s_add_u32 m0, m0, 4096
    s_nop 0
    buffer_load_dwordx4 v110, s[16:19], s99 offen offset:0 nt lds
    buffer_load_dwordx4 v110, s[16:19], s99 offen offset:1024 nt lds
    buffer_load_dwordx4 v111, s[16:19], s99 offen offset:2048 nt lds
    buffer_load_dwordx4 v111, s[16:19], s99 offen offset:3072 nt lds
    s_mov_b32 s60, 8000000
L_l2:
    ds_read_b32 v18, v7 offset:0
    s_waitcnt lgkmcnt(0)
    v_cmp_ge_u32 vcc, 2, v18
    s_nop 3
    s_cbranch_vccz L_l2go
    s_sleep 1
    s_sub_u32 s60, s60, 1
    s_cbranch_scc0 L_l2
L_l2go:
    ds_read_b128 v[64:67], v48 offset:16384
    ds_read_b128 v[68:71], v48 offset:16640
    ds_read_b128 v[72:75], v49 offset:16384
    ds_read_b128 v[76:79], v49 offset:16640
    ds_read_b128 v[80:83], v50 offset:16384
    ds_read_b128 v[84:87], v50 offset:16640
    s_waitcnt lgkmcnt(5)
    v_mfma_f32_16x16x32_bf16 v[32:35], v[64:67], v[128:131], v[32:35]
    v_mfma_f32_16x16x32_bf16 v[36:39], v[64:67], v[192:195], v[36:39]
    ds_read_b128 v[88:91], v51 offset:16384
    s_waitcnt lgkmcnt(5)
    v_mfma_f32_16x16x32_bf16 v[32:35], v[68:71], v[132:135], v[32:35]
    v_mfma_f32_16x16x32_bf16 v[36:39], v[68:71], v[196:199], v[36:39]
    ds_read_b128 v[92:95], v51 offset:16640
    s_waitcnt lgkmcnt(5)
    v_mfma_f32_16x16x32_bf16 v[32:35], v[72:75], v[136:139], v[32:35]
    v_mfma_f32_16x16x32_bf16 v[36:39], v[72:75], v[200:203], v[36:39]
    ds_read_b128 v[64:67], v52 offset:16384
    s_waitcnt lgkmcnt(5)
    v_mfma_f32_16x16x32_bf16 v[32:35], v[76:79], v[140:143], v[32:35]
    v_mfma_f32_16x16x32_bf16 v[36:39], v[76:79], v[204:207], v[36:39]
    ds_read_b128 v[68:71], v52 offset:16640
    s_waitcnt lgkmcnt(5)
    v_mfma_f32_16x16x32_bf16 v[32:35], v[80:83], v[144:147], v[32:35]
    v_mfma_f32_16x16x32_bf16 v[36:39], v[80:83], v[208:211], v[36:39]
    ds_read_b128 v[72:75], v53 offset:16384
    s_waitcnt lgkmcnt(5)
    v_mfma_f32_16x16x32_bf16 v[32:35], v[84:87], v[148:151], v[32:35]
    v_mfma_f32_16x16x32_bf16 v[36:39], v[84:87], v[212:215], v[36:39]
    ds_read_b128 v[76:79], v53 offset:16640
    s_waitcnt lgkmcnt(5)
    v_mfma_f32_16x16x32_bf16 v[32:35], v[88:91], v[152:155], v[32:35]
    v_mfma_f32_16x16x32_bf16 v[36:39], v[88:91], v[216:219], v[36:39]
    ds_read_b128 v[80:83], v54 offset:16384
    s_waitcnt lgkmcnt(5)
    v_mfma_f32_16x16x32_bf16 v[32:35], v[92:95], v[156:159], v[32:35]
    v_mfma_f32_16x16x32_bf16 v[36:39], v[92:95], v[220:223], v[36:39]
    ds_read_b128 v[84:87], v54 offset:16640
    s_waitcnt lgkmcnt(5)
    v_mfma_f32_16x16x32_bf16 v[32:35], v[64:67], v[160:163], v[32:35]
    v_mfma_f32_16x16x32_bf16 v[36:39], v[64:67], v[224:227], v[36:39]
    ds_read_b128 v[88:91], v55 offset:16384
    s_waitcnt lgkmcnt(5)
    v_mfma_f32_16x16x32_bf16 v[32:35], v[68:71], v[164:167], v[32:35]
    v_mfma_f32_16x16x32_bf16 v[36:39], v[68:71], v[228:231], v[36:39]
    ds_read_b128 v[92:95], v55 offset:16640
    s_waitcnt lgkmcnt(5)
    v_mfma_f32_16x16x32_bf16 v[32:35], v[72:75], v[168:171], v[32:35]
    v_mfma_f32_16x16x32_bf16 v[36:39], v[72:75], v[232:235], v[36:39]
    s_waitcnt lgkmcnt(4)
    v_mfma_f32_16x16x32_bf16 v[32:35], v[76:79], v[172:175], v[32:35]
    v_mfma_f32_16x16x32_bf16 v[36:39], v[76:79], v[236:239], v[36:39]
    s_waitcnt lgkmcnt(3)
    v_mfma_f32_16x16x32_bf16 v[32:35], v[80:83], v[176:179], v[32:35]
    v_mfma_f32_16x16x32_bf16 v[36:39], v[80:83], v[240:243], v[36:39]
    s_waitcnt lgkmcnt(2)
    v_mfma_f32_16x16x32_bf16 v[32:35], v[84:87], v[180:183], v[32:35]
    v_mfma_f32_16x16x32_bf16 v[36:39], v[84:87], v[244:247], v[36:39]
    s_waitcnt lgkmcnt(1)
    v_mfma_f32_16x16x32_bf16 v[32:35], v[88:91], v[184:187], v[32:35]
    v_mfma_f32_16x16x32_bf16 v[36:39], v[88:91], v[248:251], v[36:39]
    s_waitcnt lgkmcnt(0)
    v_mfma_f32_16x16x32_bf16 v[32:35], v[92:95], v[188:191], v[32:35]
    v_mfma_f32_16x16x32_bf16 v[36:39], v[92:95], v[252:255], v[36:39]
    s_nop 6
    v_exp_f32 v44, v32
    v_exp_f32 v45, v33
    v_exp_f32 v46, v34
    v_exp_f32 v47, v35
    v_max3_f32 v19, v32, v33, v34
    v_max3_f32 v19, v35, v36, v19
    v_cvt_pk_bf16_f32 v40, v44, v45
    v_cvt_pk_bf16_f32 v41, v46, v47
    ds_write_b64 v8, v[40:41] offset:8192
    v_exp_f32 v44, v36
    v_exp_f32 v45, v37
    v_exp_f32 v46, v38
    v_exp_f32 v47, v39
    v_max3_f32 v19, v37, v38, v19
    v_max_f32 v19, v39, v19
    v_cmp_lt_f32 vcc, s98, v19
    v_cvt_pk_bf16_f32 v42, v44, v45
    v_cvt_pk_bf16_f32 v43, v46, v47
    ds_write_b64 v8, v[42:43] offset:8448
    s_cmp_eq_u64 vcc, 0
    s_cselect_b32 s91, 2, 1
    v_mov_b32 v18, s91
    ds_write_b32 v7, v18 offset:128
    s_mov_b32 s60, 8000000
L_c2:
    ds_read_b32 v18, v10 offset:128
    s_waitcnt lgkmcnt(0)
    v_cmp_ne_u32 vcc, 2, v18
    s_nop 3
    s_cbranch_vccnz L_cs2
L_cg2:
    v_dot2_f32_bf16 v14, v40, s57, v14
    v_dot2_f32_bf16 v15, v42, s57, v15
    v_dot2_f32_bf16 v14, v41, s57, v14
    v_dot2_f32_bf16 v15, v43, s57, v15
    s_mov_b32 s60, 8000000
    v_mov_b32 v32, v12
    v_mov_b32 v33, v12
    v_mov_b32 v34, v12
    v_mov_b32 v35, v12
    v_mov_b32 v36, v13
    v_mov_b32 v37, v13
    v_mov_b32 v38, v13
    v_mov_b32 v39, v13
L_l3:
    ds_read_b32 v18, v7 offset:0
    s_waitcnt lgkmcnt(0)
    v_cmp_ge_u32 vcc, 3, v18
    s_nop 3
    s_cbranch_vccz L_l3go
    s_sleep 1
    s_sub_u32 s60, s60, 1
    s_cbranch_scc0 L_l3
L_l3go:
    s_waitcnt vmcnt(0)
    ds_read_b128 v[64:67], v48 offset:0
    ds_read_b128 v[68:71], v48 offset:256
    ds_read_b128 v[72:75], v49 offset:0
    ds_read_b128 v[76:79], v49 offset:256
    ds_read_b128 v[80:83], v50 offset:0
    ds_read_b128 v[84:87], v50 offset:256
    s_waitcnt lgkmcnt(5)
    v_mfma_f32_16x16x32_bf16 v[32:35], v[64:67], v[128:131], v[32:35]
    v_mfma_f32_16x16x32_bf16 v[36:39], v[64:67], v[192:195], v[36:39]
    ds_read_b128 v[88:91], v51 offset:0
    s_waitcnt lgkmcnt(5)
    v_mfma_f32_16x16x32_bf16 v[32:35], v[68:71], v[132:135], v[32:35]
    v_mfma_f32_16x16x32_bf16 v[36:39], v[68:71], v[196:199], v[36:39]
    ds_read_b128 v[92:95], v51 offset:256
    s_waitcnt lgkmcnt(5)
    v_mfma_f32_16x16x32_bf16 v[32:35], v[72:75], v[136:139], v[32:35]
    v_mfma_f32_16x16x32_bf16 v[36:39], v[72:75], v[200:203], v[36:39]
    ds_read_b128 v[64:67], v52 offset:0
    s_waitcnt lgkmcnt(5)
    v_mfma_f32_16x16x32_bf16 v[32:35], v[76:79], v[140:143], v[32:35]
    v_mfma_f32_16x16x32_bf16 v[36:39], v[76:79], v[204:207], v[36:39]
    ds_read_b128 v[68:71], v52 offset:256
    s_waitcnt lgkmcnt(5)
    v_mfma_f32_16x16x32_bf16 v[32:35], v[80:83], v[144:147], v[32:35]
    v_mfma_f32_16x16x32_bf16 v[36:39], v[80:83], v[208:211], v[36:39]
    ds_read_b128 v[72:75], v53 offset:0
    s_waitcnt lgkmcnt(5)
    v_mfma_f32_16x16x32_bf16 v[32:35], v[84:87], v[148:151], v[32:35]
    v_mfma_f32_16x16x32_bf16 v[36:39], v[84:87], v[212:215], v[36:39]
    ds_read_b128 v[76:79], v53 offset:256
    s_waitcnt lgkmcnt(5)
    v_mfma_f32_16x16x32_bf16 v[32:35], v[88:91], v[152:155], v[32:35]
    v_mfma_f32_16x16x32_bf16 v[36:39], v[88:91], v[216:219], v[36:39]
    ds_read_b128 v[80:83], v54 offset:0
    s_waitcnt lgkmcnt(5)
    v_mfma_f32_16x16x32_bf16 v[32:35], v[92:95], v[156:159], v[32:35]
    v_mfma_f32_16x16x32_bf16 v[36:39], v[92:95], v[220:223], v[36:39]
    ds_read_b128 v[84:87], v54 offset:256
    s_waitcnt lgkmcnt(5)
    v_mfma_f32_16x16x32_bf16 v[32:35], v[64:67], v[160:163], v[32:35]
    v_mfma_f32_16x16x32_bf16 v[36:39], v[64:67], v[224:227], v[36:39]
    ds_read_b128 v[88:91], v55 offset:0
    s_waitcnt lgkmcnt(5)
    v_mfma_f32_16x16x32_bf16 v[32:35], v[68:71], v[164:167], v[32:35]
    v_mfma_f32_16x16x32_bf16 v[36:39], v[68:71], v[228:231], v[36:39]
    ds_read_b128 v[92:95], v55 offset:256
    s_waitcnt lgkmcnt(5)
    v_mfma_f32_16x16x32_bf16 v[32:35], v[72:75], v[168:171], v[32:35]
    v_mfma_f32_16x16x32_bf16 v[36:39], v[72:75], v[232:235], v[36:39]
    s_waitcnt lgkmcnt(4)
    v_mfma_f32_16x16x32_bf16 v[32:35], v[76:79], v[172:175], v[32:35]
    v_mfma_f32_16x16x32_bf16 v[36:39], v[76:79], v[236:239], v[36:39]
    s_waitcnt lgkmcnt(3)
    v_mfma_f32_16x16x32_bf16 v[32:35], v[80:83], v[176:179], v[32:35]
    v_mfma_f32_16x16x32_bf16 v[36:39], v[80:83], v[240:243], v[36:39]
    s_waitcnt lgkmcnt(2)
    v_mfma_f32_16x16x32_bf16 v[32:35], v[84:87], v[180:183], v[32:35]
    v_mfma_f32_16x16x32_bf16 v[36:39], v[84:87], v[244:247], v[36:39]
    s_waitcnt lgkmcnt(1)
    v_mfma_f32_16x16x32_bf16 v[32:35], v[88:91], v[184:187], v[32:35]
    v_mfma_f32_16x16x32_bf16 v[36:39], v[88:91], v[248:251], v[36:39]
    s_waitcnt lgkmcnt(0)
    v_mfma_f32_16x16x32_bf16 v[32:35], v[92:95], v[188:191], v[32:35]
    v_mfma_f32_16x16x32_bf16 v[36:39], v[92:95], v[252:255], v[36:39]
    s_nop 6
    v_exp_f32 v44, v32
    v_exp_f32 v45, v33
    v_exp_f32 v46, v34
    v_exp_f32 v47, v35
    v_max3_f32 v19, v32, v33, v34
    v_max3_f32 v19, v35, v36, v19
    v_cvt_pk_bf16_f32 v40, v44, v45
    v_cvt_pk_bf16_f32 v41, v46, v47
    ds_write_b64 v8, v[40:41] offset:12288
    v_exp_f32 v44, v36
    v_exp_f32 v45, v37
    v_exp_f32 v46, v38
    v_exp_f32 v47, v39
    v_max3_f32 v19, v37, v38, v19
    v_max_f32 v19, v39, v19
    v_cmp_lt_f32 vcc, s98, v19
    v_cvt_pk_bf16_f32 v42, v44, v45
    v_cvt_pk_bf16_f32 v43, v46, v47
    ds_write_b64 v8, v[42:43] offset:12544
    s_cmp_eq_u64 vcc, 0
    s_cselect_b32 s91, 2, 1
    v_mov_b32 v18, s91
    ds_write_b32 v7, v18 offset:144
    s_lshl_b32 s94, s4, 2
    s_add_u32 s94, s94, 16
    s_cmp_lg_u32 s3, 0
    s_cbranch_scc1 arr_66
    v_mov_b32 v31, s94
    v_mov_b32 v30, 1
    s_mov_b64 exec, 1
    global_atomic_add v30, v31, v30, s[86:87] sc0 sc1
    s_mov_b64 exec, -1
arr_66:
    s_mov_b32 s60, 8000000
L_c3:
    ds_read_b32 v18, v10 offset:144
    s_waitcnt lgkmcnt(0)
    v_cmp_ne_u32 vcc, 2, v18
    s_nop 3
    s_cbranch_vccnz L_cs3
L_cg3:
    v_dot2_f32_bf16 v14, v40, s57, v14
    v_dot2_f32_bf16 v15, v42, s57, v15
    v_dot2_f32_bf16 v14, v41, s57, v14
    v_dot2_f32_bf16 v15, v43, s57, v15
    s_lshl_b32 s94, s4, 2
    s_add_u32 s94, s94, 16
    s_nop 0
    v_permlane16_swap_b32 v14, v15
    v_add_f32 v14, v14, v15
    v_mov_b32 v15, v14
    s_nop 1
    v_permlane32_swap_b32 v14, v15
    v_add_f32 v14, v14, v15
    ds_write_b32 v6, v14
    ds_write_b32 v7, v0 offset:64
    s_cmp_lg_u32 s3, 0
    s_cbranch_scc1 L_norel2
    s_lshl_b32 s94, s4, 14
    s_add_u32 s94, s94, 655360
    s_add_u32 s95, s94, 8192
    v_lshlrev_b32 v31, 7, v1
    v_mov_b32 v29, s56
    s_waitcnt vmcnt(0)
    v_readfirstlane_b32 s1, v30
    s_nop 0
    s_and_b32 s1, s1, 31
    s_cmp_lg_u32 s1, 31
    s_nop 0
    s_cbranch_scc1 L_norel2
    s_mov_b32 s60, 8000000
lw_67:
    ds_read_b32 v18, v10 offset:48
    s_waitcnt lgkmcnt(0)
    v_cmp_gt_u32 vcc, 6, v18
    s_nop 3
    s_cbranch_vccz lwd_68
    s_sub_u32 s60, s60, 1
    s_cbranch_scc0 lw_67
lwd_68:
    s_mov_b32 exec_lo, 0xffffffff
    s_mov_b32 exec_hi, 0x0
    buffer_store_dword v29, v31, s[12:15], s94 offen sc1
L_norel2:
L_send:
    s_endpgm
L_cs1:
    v_cmp_eq_u32 vcc, 0, v18
    s_nop 3
    s_cbranch_vccz L_ex1
    s_sub_u32 s60, s60, 1
    s_cbranch_scc0 L_c1
    s_branch L_cg1
L_ex1:
    s_add_u32 s96, s96, 1
    v_mov_b32 v18, s96
    v_max3_f32 v16, v32, v33, v34
    v_max3_f32 v16, v16, v35, 0
    v_max3_f32 v17, v36, v37, v38
    v_max3_f32 v17, v17, v39, 0
    s_nop 1
    v_permlane16_swap_b32 v16, v17
    v_max_f32 v16, v16, v17
    v_mov_b32 v17, v16
    s_nop 1
    v_permlane32_swap_b32 v16, v17
    v_max_f32 v16, v16, v17
    ds_write_b32 v6, v16
    ds_write_b32 v7, v18 offset:32
    s_mov_b32 s60, 8000000
L_mx1:
    ds_read_b32 v18, v10 offset:32
    ds_read_b128 v[64:67], v9
    ds_read_b128 v[68:71], v9 offset:256
    s_waitcnt lgkmcnt(0)
    v_cmp_gt_u32 vcc, s96, v18
    s_nop 3
    s_cbranch_vccz L_mx1go
    s_sub_u32 s60, s60, 1
    s_cbranch_scc0 L_mx1
L_mx1go:
    v_max3_f32 v16, v64, v65, v66
    v_max_f32 v16, v16, v67
    v_sub_f32 v32, v32, v16
    v_sub_f32 v33, v33, v16
    v_sub_f32 v34, v34, v16
    v_sub_f32 v35, v35, v16
    v_max3_f32 v17, v68, v69, v70
    v_max_f32 v17, v17, v71
    v_sub_f32 v36, v36, v17
    v_sub_f32 v37, v37, v17
    v_sub_f32 v38, v38, v17
    v_sub_f32 v39, v39, v17
    v_exp_f32 v20, -v16
    v_sub_f32 v12, v12, v16
    v_sub_f32 v22, 0, v12
    v_mul_f32 v14, v14, v20
    v_exp_f32 v21, -v17
    v_sub_f32 v13, v13, v17
    v_sub_f32 v23, 0, v13
    v_mul_f32 v15, v15, v21
    ds_write2_b32 v11, v20, v21 offset0:32 offset1:48
    ds_write2_b32 v11, v22, v23 offset0:128 offset1:144
    v_exp_f32 v44, v32
    v_exp_f32 v45, v33
    v_exp_f32 v46, v34
    v_exp_f32 v47, v35
    v_cvt_pk_bf16_f32 v40, v44, v45
    v_cvt_pk_bf16_f32 v41, v46, v47
    ds_write_b64 v8, v[40:41] offset:4096
    v_exp_f32 v44, v36
    v_exp_f32 v45, v37
    v_exp_f32 v46, v38
    v_exp_f32 v47, v39
    v_cvt_pk_bf16_f32 v42, v44, v45
    v_cvt_pk_bf16_f32 v43, v46, v47
    ds_write_b64 v8, v[42:43] offset:4352
    v_mov_b32 v18, 3
    ds_write_b32 v7, v18 offset:112
    s_mov_b32 s60, 8000000
lw_69:
    ds_read_b32 v18, v10 offset:112
    s_waitcnt lgkmcnt(0)
    v_cmp_gt_u32 vcc, 3, v18
    s_nop 3
    s_cbranch_vccz lwd_70
    s_sub_u32 s60, s60, 1
    s_cbranch_scc0 lw_69
lwd_70:
    s_branch L_cg1
L_cs2:
    v_cmp_eq_u32 vcc, 0, v18
    s_nop 3
    s_cbranch_vccz L_ex2
    s_sub_u32 s60, s60, 1
    s_cbranch_scc0 L_c2
    s_branch L_cg2
L_ex2:
    s_add_u32 s96, s96, 1
    v_mov_b32 v18, s96
    v_max3_f32 v16, v32, v33, v34
    v_max3_f32 v16, v16, v35, 0
    v_max3_f32 v17, v36, v37, v38
    v_max3_f32 v17, v17, v39, 0
    s_nop 1
    v_permlane16_swap_b32 v16, v17
    v_max_f32 v16, v16, v17
    v_mov_b32 v17, v16
    s_nop 1
    v_permlane32_swap_b32 v16, v17
    v_max_f32 v16, v16, v17
    ds_write_b32 v6, v16
    ds_write_b32 v7, v18 offset:32
    s_mov_b32 s60, 8000000
L_mx2:
    ds_read_b32 v18, v10 offset:32
    ds_read_b128 v[64:67], v9
    ds_read_b128 v[68:71], v9 offset:256
    s_waitcnt lgkmcnt(0)
    v_cmp_gt_u32 vcc, s96, v18
    s_nop 3
    s_cbranch_vccz L_mx2go
    s_sub_u32 s60, s60, 1
    s_cbranch_scc0 L_mx2
L_mx2go:
    v_max3_f32 v16, v64, v65, v66
    v_max_f32 v16, v16, v67
    v_sub_f32 v32, v32, v16
    v_sub_f32 v33, v33, v16
    v_sub_f32 v34, v34, v16
    v_sub_f32 v35, v35, v16
    v_max3_f32 v17, v68, v69, v70
    v_max_f32 v17, v17, v71
    v_sub_f32 v36, v36, v17
    v_sub_f32 v37, v37, v17
    v_sub_f32 v38, v38, v17
    v_sub_f32 v39, v39, v17
    v_exp_f32 v20, -v16
    v_sub_f32 v12, v12, v16
    v_sub_f32 v22, 0, v12
    v_mul_f32 v14, v14, v20
    v_exp_f32 v21, -v17
    v_sub_f32 v13, v13, v17
    v_sub_f32 v23, 0, v13
    v_mul_f32 v15, v15, v21
    ds_write2_b32 v11, v20, v21 offset0:64 offset1:80
    ds_write2_b32 v11, v22, v23 offset0:128 offset1:144
    v_exp_f32 v44, v32
    v_exp_f32 v45, v33
    v_exp_f32 v46, v34
    v_exp_f32 v47, v35
    v_cvt_pk_bf16_f32 v40, v44, v45
    v_cvt_pk_bf16_f32 v41, v46, v47
    ds_write_b64 v8, v[40:41] offset:8192
    v_exp_f32 v44, v36
    v_exp_f32 v45, v37
    v_exp_f32 v46, v38
    v_exp_f32 v47, v39
    v_cvt_pk_bf16_f32 v42, v44, v45
    v_cvt_pk_bf16_f32 v43, v46, v47
    ds_write_b64 v8, v[42:43] offset:8448
    v_mov_b32 v18, 3
    ds_write_b32 v7, v18 offset:128
    s_mov_b32 s60, 8000000
lw_71:
    ds_read_b32 v18, v10 offset:128
    s_waitcnt lgkmcnt(0)
    v_cmp_gt_u32 vcc, 3, v18
    s_nop 3
    s_cbranch_vccz lwd_72
    s_sub_u32 s60, s60, 1
    s_cbranch_scc0 lw_71
lwd_72:
    s_branch L_cg2
L_cs3:
    v_cmp_eq_u32 vcc, 0, v18
    s_nop 3
    s_cbranch_vccz L_ex3
    s_sub_u32 s60, s60, 1
    s_cbranch_scc0 L_c3
    s_branch L_cg3
L_ex3:
    s_add_u32 s96, s96, 1
    v_mov_b32 v18, s96
    v_max3_f32 v16, v32, v33, v34
    v_max3_f32 v16, v16, v35, 0
    v_max3_f32 v17, v36, v37, v38
    v_max3_f32 v17, v17, v39, 0
    s_nop 1
    v_permlane16_swap_b32 v16, v17
    v_max_f32 v16, v16, v17
    v_mov_b32 v17, v16
    s_nop 1
    v_permlane32_swap_b32 v16, v17
    v_max_f32 v16, v16, v17
    ds_write_b32 v6, v16
    ds_write_b32 v7, v18 offset:32
    s_mov_b32 s60, 8000000
L_mx3:
    ds_read_b32 v18, v10 offset:32
    ds_read_b128 v[64:67], v9
    ds_read_b128 v[68:71], v9 offset:256
    s_waitcnt lgkmcnt(0)
    v_cmp_gt_u32 vcc, s96, v18
    s_nop 3
    s_cbranch_vccz L_mx3go
    s_sub_u32 s60, s60, 1
    s_cbranch_scc0 L_mx3
L_mx3go:
    v_max3_f32 v16, v64, v65, v66
    v_max_f32 v16, v16, v67
    v_sub_f32 v32, v32, v16
    v_sub_f32 v33, v33, v16
    v_sub_f32 v34, v34, v16
    v_sub_f32 v35, v35, v16
    v_max3_f32 v17, v68, v69, v70
    v_max_f32 v17, v17, v71
    v_sub_f32 v36, v36, v17
    v_sub_f32 v37, v37, v17
    v_sub_f32 v38, v38, v17
    v_sub_f32 v39, v39, v17
    v_exp_f32 v20, -v16
    v_sub_f32 v12, v12, v16
    v_sub_f32 v22, 0, v12
    v_mul_f32 v14, v14, v20
    v_exp_f32 v21, -v17
    v_sub_f32 v13, v13, v17
    v_sub_f32 v23, 0, v13
    v_mul_f32 v15, v15, v21
    ds_write2_b32 v11, v20, v21 offset0:96 offset1:112
    ds_write2_b32 v11, v22, v23 offset0:128 offset1:144
    v_exp_f32 v44, v32
    v_exp_f32 v45, v33
    v_exp_f32 v46, v34
    v_exp_f32 v47, v35
    v_cvt_pk_bf16_f32 v40, v44, v45
    v_cvt_pk_bf16_f32 v41, v46, v47
    ds_write_b64 v8, v[40:41] offset:12288
    v_exp_f32 v44, v36
    v_exp_f32 v45, v37
    v_exp_f32 v46, v38
    v_exp_f32 v47, v39
    v_cvt_pk_bf16_f32 v42, v44, v45
    v_cvt_pk_bf16_f32 v43, v46, v47
    ds_write_b64 v8, v[42:43] offset:12544
    v_mov_b32 v18, 3
    ds_write_b32 v7, v18 offset:144
    s_mov_b32 s60, 8000000
lw_73:
    ds_read_b32 v18, v10 offset:144
    s_waitcnt lgkmcnt(0)
    v_cmp_gt_u32 vcc, 3, v18
    s_nop 3
    s_cbranch_vccz lwd_74
    s_sub_u32 s60, s60, 1
    s_cbranch_scc0 lw_73
lwd_74:
    s_branch L_cg3
L_end:
    s_endpgm
.section .rodata,"a"
.p2align 6
.amdhsa_kernel sequential_preLN__compressed_kv_cla__glu_gated_geglu__decode_kernel
  .amdhsa_next_free_vgpr 256
  .amdhsa_next_free_sgpr 102
  .amdhsa_accum_offset 256
  .amdhsa_group_segment_fixed_size 0
  .amdhsa_kernarg_size 104
  .amdhsa_user_sgpr_count 2
  .amdhsa_user_sgpr_kernarg_segment_ptr 1
  .amdhsa_system_sgpr_workgroup_id_x 1
.end_amdhsa_kernel
```
